```python
import torch

def _softmax(x, axis=-1):
    return torch.softmax(x, dim=axis)
def _gelu(x):
    return torch.nn.functional.gelu(x, approximate="tanh")
def _silu(x):
    return torch.nn.functional.silu(x)
def _sigmoid(x):
    return torch.sigmoid(x)
def _layernorm(x, axis=-1, eps=1e-5):
    m = x.mean(dim=axis, keepdim=True)
    v = x.var(dim=axis, keepdim=True, unbiased=False)
    return (x - m) / torch.sqrt(v + eps)
def _scatter_add(tgt, idx, src, axis=0):
    return tgt.clone().index_add_(axis, idx, src)
def _segment_sum(src, seg, n):
    out = torch.zeros((n,) + src.shape[1:], dtype=src.dtype)
    return out.index_add_(0, seg, src)
def _pad(x, pw):
    flat = tuple(v for pair in reversed(pw) for v in pair)
    return torch.nn.functional.pad(x, flat)

kernel_name = 'standalone__softmax_full_bidir__prompt'

def setup_inputs():

    _w = (lambda a: (lambda t: t.to(torch.bfloat16) if t.is_floating_point() else t)(torch.as_tensor(a)))
    B, H, Sq, Skv, Dh = 1, 16, 2048, 2048, 256
    return {
        "q": _w((lambda *s: torch.randn(*s, dtype=torch.bfloat16) * 0.8)(B, H, Sq, Dh)),
        "k": _w((lambda *s: torch.randn(*s, dtype=torch.bfloat16) * 0.8)(B, H, Skv, Dh)),
        "v": _w((lambda *s: torch.randn(*s, dtype=torch.bfloat16) * 0.05)(B, H, Skv, Dh)),
    }

def reference(q, k, v):
    scale = q.shape[-1] ** -0.5
    scores = torch.einsum('bhqd,bhkd->bhqk', q, k) * scale
    attn = _softmax(scores, axis=-1)
    return torch.einsum('bhqk,bhkd->bhqd', attn, v)
```

```asm
; @launch grid=(256,1,1) block=(512,1,1) lds=163840
.amdgcn_target "amdgcn-amd-amdhsa--gfx950"
.text
.globl standalone__softmax_full_bidir__prompt_kernel
.p2align 8
.type standalone__softmax_full_bidir__prompt_kernel,@function
standalone__softmax_full_bidir__prompt_kernel:
    s_cmp_ge_u32 s2, 256
    s_cbranch_scc1 L_done
    s_load_dwordx4 s[4:7], s[0:1], 0
    s_load_dwordx4 s[8:11], s[0:1], 16
    v_lshrrev_b32 v1, 6, v0
    v_and_b32 v2, 63, v0
    v_readfirstlane_b32 s36, v1
    s_and_b32 s48, s2, 7
    s_lshr_b32 s49, s2, 3
    s_lshr_b32 s50, s49, 4
    s_lshl_b32 s37, s48, 1
    s_add_u32 s37, s37, s50
    s_and_b32 s38, s49, 15
    s_lshl_b32 s48, s37, 20
    s_lshl_b32 s49, s38, 16
    s_add_u32 s53, s48, s49
    s_mov_b32 s39, 0
    v_and_b32 v3, 15, v2
    v_lshrrev_b32 v1, 4, v2
    v_lshrrev_b32 v4, 5, v2
    v_and_b32 v6, 31, v2
    s_cmp_ge_u32 s36, 4
    s_cbranch_scc1 L_pv
    v_lshlrev_b32 v5, 4, v2
    s_lshl_b32 s48, s36, 10
    v_add_u32 v5, s48, v5
    s_waitcnt lgkmcnt(0)
    s_mov_b32 s16, s4
    s_mov_b32 s17, s5
    s_mov_b32 s18, 0x1000000
    s_mov_b32 s19, 0x20000
    s_setprio 1
    s_add_u32 s48, s53, 0
    buffer_load_dwordx4 v[96:99], v5, s[16:19], s48 offen nt
    s_add_u32 s48, s53, 4096
    buffer_load_dwordx4 v[100:103], v5, s[16:19], s48 offen nt
    s_add_u32 s48, s53, 32768
    buffer_load_dwordx4 v[104:107], v5, s[16:19], s48 offen nt
    s_add_u32 s48, s53, 36864
    buffer_load_dwordx4 v[108:111], v5, s[16:19], s48 offen nt
    s_add_u32 s48, s53, 8192
    buffer_load_dwordx4 v[112:115], v5, s[16:19], s48 offen nt
    s_add_u32 s48, s53, 12288
    buffer_load_dwordx4 v[116:119], v5, s[16:19], s48 offen nt
    s_add_u32 s48, s53, 40960
    buffer_load_dwordx4 v[120:123], v5, s[16:19], s48 offen nt
    s_add_u32 s48, s53, 45056
    buffer_load_dwordx4 v[124:127], v5, s[16:19], s48 offen nt
    v_mov_b32 v79, v5
    s_setprio 2
    s_mov_b32 s46, 0x3db8aa3b
    s_mov_b32 s47, 0x3db8aa3b
    s_lshl_b32 s48, s36, 1
    s_add_u32 s48, s48, 0
    v_add_u32 v7, s48, v4
    v_xor_b32 v5, v6, v7
    v_lshlrev_b32 v5, 4, v5
    v_lshl_add_u32 v5, v7, 9, v5
    v_add_u32 v13, 98304, v5
    s_lshl_b32 s48, s36, 1
    s_add_u32 s48, s48, 8
    v_add_u32 v7, s48, v4
    v_xor_b32 v5, v6, v7
    v_lshlrev_b32 v5, 4, v5
    v_lshl_add_u32 v5, v7, 9, v5
    v_add_u32 v0, 98304, v5
    s_lshr_b32 s49, s36, 1
    s_lshl_b32 s50, s49, 14
    v_lshlrev_b32 v6, 9, v3
    s_and_b32 s48, s36, 1
    s_lshl_b32 s51, s48, 15
    s_add_u32 s51, s51, 98304
    v_add_u32 v7, 0, v1
    v_xor_b32 v7, v7, v3
    v_lshl_add_u32 v7, v7, 4, v6
    v_add_u32 v8, s50, v7
    v_add_u32 v4, s51, v7
    v_add_u32 v7, 4, v1
    v_xor_b32 v7, v7, v3
    v_lshl_add_u32 v7, v7, 4, v6
    v_add_u32 v9, s50, v7
    v_add_u32 v5, s51, v7
    v_add_u32 v7, 8, v1
    v_xor_b32 v7, v7, v3
    v_lshl_add_u32 v7, v7, 4, v6
    v_add_u32 v10, s50, v7
    v_add_u32 v14, s51, v7
    v_add_u32 v7, 12, v1
    v_xor_b32 v7, v7, v3
    v_lshl_add_u32 v7, v7, 4, v6
    v_add_u32 v11, s50, v7
    v_add_u32 v15, s51, v7
    s_lshl_b32 s48, s48, 1
    s_add_u32 s54, s48, s49
    s_lshl_b32 s50, s54, 12
    s_add_u32 s50, s50, 131072
    v_lshlrev_b32 v7, 4, v2
    v_add_u32 v12, s50, v7
    s_waitcnt vmcnt(4)
    v_lshlrev_b32 v80, 16, v96
    v_and_b32 v81, 0xffff0000, v96
    v_lshlrev_b32 v82, 16, v97
    v_and_b32 v83, 0xffff0000, v97
    v_lshlrev_b32 v84, 16, v98
    v_and_b32 v85, 0xffff0000, v98
    v_lshlrev_b32 v86, 16, v99
    v_and_b32 v87, 0xffff0000, v99
    v_lshlrev_b32 v88, 16, v100
    v_and_b32 v89, 0xffff0000, v100
    v_lshlrev_b32 v90, 16, v101
    v_and_b32 v91, 0xffff0000, v101
    v_lshlrev_b32 v92, 16, v102
    v_and_b32 v93, 0xffff0000, v102
    v_lshlrev_b32 v94, 16, v103
    v_and_b32 v95, 0xffff0000, v103
    v_pk_mul_f32 v[80:81], v[80:81], s[46:47]
    v_pk_mul_f32 v[82:83], v[82:83], s[46:47]
    v_pk_mul_f32 v[84:85], v[84:85], s[46:47]
    v_pk_mul_f32 v[86:87], v[86:87], s[46:47]
    v_pk_mul_f32 v[88:89], v[88:89], s[46:47]
    v_pk_mul_f32 v[90:91], v[90:91], s[46:47]
    v_pk_mul_f32 v[92:93], v[92:93], s[46:47]
    v_pk_mul_f32 v[94:95], v[94:95], s[46:47]
    v_cvt_pk_bf16_f32 v96, v80, v81
    v_cvt_pk_bf16_f32 v97, v82, v83
    v_cvt_pk_bf16_f32 v98, v84, v85
    v_cvt_pk_bf16_f32 v99, v86, v87
    v_cvt_pk_bf16_f32 v100, v88, v89
    v_cvt_pk_bf16_f32 v101, v90, v91
    v_cvt_pk_bf16_f32 v102, v92, v93
    v_cvt_pk_bf16_f32 v103, v94, v95
    ds_write_b128 v13, v[96:99] offset:0
    ds_write_b128 v0, v[100:103] offset:0
    v_lshlrev_b32 v80, 16, v104
    v_and_b32 v81, 0xffff0000, v104
    v_lshlrev_b32 v82, 16, v105
    v_and_b32 v83, 0xffff0000, v105
    v_lshlrev_b32 v84, 16, v106
    v_and_b32 v85, 0xffff0000, v106
    v_lshlrev_b32 v86, 16, v107
    v_and_b32 v87, 0xffff0000, v107
    v_lshlrev_b32 v88, 16, v108
    v_and_b32 v89, 0xffff0000, v108
    v_lshlrev_b32 v90, 16, v109
    v_and_b32 v91, 0xffff0000, v109
    v_lshlrev_b32 v92, 16, v110
    v_and_b32 v93, 0xffff0000, v110
    v_lshlrev_b32 v94, 16, v111
    v_and_b32 v95, 0xffff0000, v111
    v_pk_mul_f32 v[80:81], v[80:81], s[46:47]
    v_pk_mul_f32 v[82:83], v[82:83], s[46:47]
    v_pk_mul_f32 v[84:85], v[84:85], s[46:47]
    v_pk_mul_f32 v[86:87], v[86:87], s[46:47]
    v_pk_mul_f32 v[88:89], v[88:89], s[46:47]
    v_pk_mul_f32 v[90:91], v[90:91], s[46:47]
    v_pk_mul_f32 v[92:93], v[92:93], s[46:47]
    v_pk_mul_f32 v[94:95], v[94:95], s[46:47]
    v_cvt_pk_bf16_f32 v104, v80, v81
    v_cvt_pk_bf16_f32 v105, v82, v83
    v_cvt_pk_bf16_f32 v106, v84, v85
    v_cvt_pk_bf16_f32 v107, v86, v87
    v_cvt_pk_bf16_f32 v108, v88, v89
    v_cvt_pk_bf16_f32 v109, v90, v91
    v_cvt_pk_bf16_f32 v110, v92, v93
    v_cvt_pk_bf16_f32 v111, v94, v95
    ds_write_b128 v13, v[104:107] offset:32768
    ds_write_b128 v0, v[108:111] offset:32768
    s_add_u32 s48, s53, 16384
    buffer_load_dwordx4 v[128:131], v79, s[16:19], s48 offen nt
    s_add_u32 s48, s53, 20480
    buffer_load_dwordx4 v[132:135], v79, s[16:19], s48 offen nt
    s_add_u32 s48, s53, 49152
    buffer_load_dwordx4 v[136:139], v79, s[16:19], s48 offen nt
    s_add_u32 s48, s53, 53248
    buffer_load_dwordx4 v[140:143], v79, s[16:19], s48 offen nt
    s_add_u32 s48, s53, 24576
    buffer_load_dwordx4 v[160:163], v79, s[16:19], s48 offen nt
    s_add_u32 s48, s53, 28672
    buffer_load_dwordx4 v[164:167], v79, s[16:19], s48 offen nt
    s_add_u32 s48, s53, 57344
    buffer_load_dwordx4 v[168:171], v79, s[16:19], s48 offen nt
    s_add_u32 s48, s53, 61440
    buffer_load_dwordx4 v[172:175], v79, s[16:19], s48 offen nt
    s_waitcnt lgkmcnt(0)
    s_barrier
    ds_read_b128 a[0:3], v4 offset:0
    ds_read_b128 a[4:7], v5 offset:0
    ds_read_b128 a[8:11], v14 offset:0
    ds_read_b128 a[12:15], v15 offset:0
    ds_read_b128 a[16:19], v4 offset:256
    ds_read_b128 a[20:23], v5 offset:256
    ds_read_b128 a[24:27], v14 offset:256
    ds_read_b128 a[28:31], v15 offset:256
    s_waitcnt lgkmcnt(0)
    ds_read_b128 v[16:19], v8 offset:0
    ds_read_b128 v[20:23], v9 offset:0
    ds_read_b128 v[24:27], v10 offset:0
    ds_read_b128 v[28:31], v11 offset:0
    ds_read_b128 v[32:35], v8 offset:256
    ds_read_b128 v[36:39], v9 offset:256
    ds_read_b128 v[40:43], v10 offset:256
    ds_read_b128 v[44:47], v11 offset:256
    s_waitcnt lgkmcnt(0)
    ds_read_b128 v[48:51], v8 offset:8192
    ds_read_b128 v[52:55], v9 offset:8192
    ds_read_b128 v[56:59], v10 offset:8192
    ds_read_b128 v[60:63], v11 offset:8192
    ds_read_b128 v[64:67], v8 offset:8448
    ds_read_b128 v[68:71], v9 offset:8448
    ds_read_b128 v[72:75], v10 offset:8448
    ds_read_b128 v[76:79], v11 offset:8448
    v_mfma_f32_16x16x32_bf16 v[96:99], v[16:19], a[0:3], 0
    v_mfma_f32_16x16x32_bf16 v[96:99], v[20:23], a[4:7], v[96:99]
    v_mfma_f32_16x16x32_bf16 v[96:99], v[24:27], a[8:11], v[96:99]
    v_mfma_f32_16x16x32_bf16 v[96:99], v[28:31], a[12:15], v[96:99]
    v_mfma_f32_16x16x32_bf16 v[96:99], v[32:35], a[16:19], v[96:99]
    v_mfma_f32_16x16x32_bf16 v[96:99], v[36:39], a[20:23], v[96:99]
    v_mfma_f32_16x16x32_bf16 v[96:99], v[40:43], a[24:27], v[96:99]
    v_mfma_f32_16x16x32_bf16 v[96:99], v[44:47], a[28:31], v[96:99]
    s_waitcnt lgkmcnt(7)
    v_mfma_f32_16x16x32_bf16 v[100:103], v[48:51], a[0:3], 0
    s_waitcnt lgkmcnt(6)
    v_mfma_f32_16x16x32_bf16 v[100:103], v[52:55], a[4:7], v[100:103]
    s_waitcnt lgkmcnt(5)
    v_mfma_f32_16x16x32_bf16 v[100:103], v[56:59], a[8:11], v[100:103]
    s_waitcnt lgkmcnt(4)
    v_mfma_f32_16x16x32_bf16 v[100:103], v[60:63], a[12:15], v[100:103]
    s_waitcnt lgkmcnt(3)
    v_mfma_f32_16x16x32_bf16 v[100:103], v[64:67], a[16:19], v[100:103]
    s_waitcnt lgkmcnt(2)
    v_mfma_f32_16x16x32_bf16 v[100:103], v[68:71], a[20:23], v[100:103]
    s_waitcnt lgkmcnt(1)
    v_mfma_f32_16x16x32_bf16 v[100:103], v[72:75], a[24:27], v[100:103]
    s_waitcnt lgkmcnt(0)
    v_mfma_f32_16x16x32_bf16 v[100:103], v[76:79], a[28:31], v[100:103]
    s_waitcnt lgkmcnt(0)
    s_waitcnt vmcnt(8)
    v_lshlrev_b32 v80, 16, v112
    v_and_b32 v81, 0xffff0000, v112
    v_lshlrev_b32 v82, 16, v113
    v_and_b32 v83, 0xffff0000, v113
    v_lshlrev_b32 v84, 16, v114
    v_and_b32 v85, 0xffff0000, v114
    v_lshlrev_b32 v86, 16, v115
    v_and_b32 v87, 0xffff0000, v115
    v_lshlrev_b32 v88, 16, v116
    v_and_b32 v89, 0xffff0000, v116
    v_lshlrev_b32 v90, 16, v117
    v_and_b32 v91, 0xffff0000, v117
    v_lshlrev_b32 v92, 16, v118
    v_and_b32 v93, 0xffff0000, v118
    v_lshlrev_b32 v94, 16, v119
    v_and_b32 v95, 0xffff0000, v119
    v_pk_mul_f32 v[80:81], v[80:81], s[46:47]
    v_pk_mul_f32 v[82:83], v[82:83], s[46:47]
    v_pk_mul_f32 v[84:85], v[84:85], s[46:47]
    v_pk_mul_f32 v[86:87], v[86:87], s[46:47]
    v_pk_mul_f32 v[88:89], v[88:89], s[46:47]
    v_pk_mul_f32 v[90:91], v[90:91], s[46:47]
    v_pk_mul_f32 v[92:93], v[92:93], s[46:47]
    v_pk_mul_f32 v[94:95], v[94:95], s[46:47]
    v_cvt_pk_bf16_f32 v112, v80, v81
    v_cvt_pk_bf16_f32 v113, v82, v83
    v_cvt_pk_bf16_f32 v114, v84, v85
    v_cvt_pk_bf16_f32 v115, v86, v87
    v_cvt_pk_bf16_f32 v116, v88, v89
    v_cvt_pk_bf16_f32 v117, v90, v91
    v_cvt_pk_bf16_f32 v118, v92, v93
    v_cvt_pk_bf16_f32 v119, v94, v95
    ds_write_b128 v13, v[112:115] offset:8192
    ds_write_b128 v0, v[116:119] offset:8192
    v_lshlrev_b32 v80, 16, v120
    v_and_b32 v81, 0xffff0000, v120
    v_lshlrev_b32 v82, 16, v121
    v_and_b32 v83, 0xffff0000, v121
    v_lshlrev_b32 v84, 16, v122
    v_and_b32 v85, 0xffff0000, v122
    v_lshlrev_b32 v86, 16, v123
    v_and_b32 v87, 0xffff0000, v123
    v_lshlrev_b32 v88, 16, v124
    v_and_b32 v89, 0xffff0000, v124
    v_lshlrev_b32 v90, 16, v125
    v_and_b32 v91, 0xffff0000, v125
    v_lshlrev_b32 v92, 16, v126
    v_and_b32 v93, 0xffff0000, v126
    v_lshlrev_b32 v94, 16, v127
    v_and_b32 v95, 0xffff0000, v127
    v_pk_mul_f32 v[80:81], v[80:81], s[46:47]
    v_pk_mul_f32 v[82:83], v[82:83], s[46:47]
    v_pk_mul_f32 v[84:85], v[84:85], s[46:47]
    v_pk_mul_f32 v[86:87], v[86:87], s[46:47]
    v_pk_mul_f32 v[88:89], v[88:89], s[46:47]
    v_pk_mul_f32 v[90:91], v[90:91], s[46:47]
    v_pk_mul_f32 v[92:93], v[92:93], s[46:47]
    v_pk_mul_f32 v[94:95], v[94:95], s[46:47]
    v_cvt_pk_bf16_f32 v120, v80, v81
    v_cvt_pk_bf16_f32 v121, v82, v83
    v_cvt_pk_bf16_f32 v122, v84, v85
    v_cvt_pk_bf16_f32 v123, v86, v87
    v_cvt_pk_bf16_f32 v124, v88, v89
    v_cvt_pk_bf16_f32 v125, v90, v91
    v_cvt_pk_bf16_f32 v126, v92, v93
    v_cvt_pk_bf16_f32 v127, v94, v95
    ds_write_b128 v13, v[120:123] offset:40960
    ds_write_b128 v0, v[124:127] offset:40960
    s_waitcnt lgkmcnt(0)
    s_barrier
    ds_read_b128 a[32:35], v4 offset:8192
    ds_read_b128 a[36:39], v5 offset:8192
    ds_read_b128 a[40:43], v14 offset:8192
    ds_read_b128 a[44:47], v15 offset:8192
    ds_read_b128 a[48:51], v4 offset:8448
    ds_read_b128 a[52:55], v5 offset:8448
    ds_read_b128 a[56:59], v14 offset:8448
    ds_read_b128 a[60:63], v15 offset:8448
    s_waitcnt lgkmcnt(7)
    v_mfma_f32_16x16x32_bf16 v[104:107], v[16:19], a[32:35], 0
    s_waitcnt lgkmcnt(6)
    v_mfma_f32_16x16x32_bf16 v[104:107], v[20:23], a[36:39], v[104:107]
    s_waitcnt lgkmcnt(5)
    v_mfma_f32_16x16x32_bf16 v[104:107], v[24:27], a[40:43], v[104:107]
    s_waitcnt lgkmcnt(4)
    v_mfma_f32_16x16x32_bf16 v[104:107], v[28:31], a[44:47], v[104:107]
    s_waitcnt lgkmcnt(3)
    v_mfma_f32_16x16x32_bf16 v[104:107], v[32:35], a[48:51], v[104:107]
    s_waitcnt lgkmcnt(2)
    v_mfma_f32_16x16x32_bf16 v[104:107], v[36:39], a[52:55], v[104:107]
    s_waitcnt lgkmcnt(1)
    v_mfma_f32_16x16x32_bf16 v[104:107], v[40:43], a[56:59], v[104:107]
    s_waitcnt lgkmcnt(0)
    v_mfma_f32_16x16x32_bf16 v[104:107], v[44:47], a[60:63], v[104:107]
    v_mfma_f32_16x16x32_bf16 v[108:111], v[48:51], a[32:35], 0
    v_mfma_f32_16x16x32_bf16 v[108:111], v[52:55], a[36:39], v[108:111]
    v_mfma_f32_16x16x32_bf16 v[108:111], v[56:59], a[40:43], v[108:111]
    v_mfma_f32_16x16x32_bf16 v[108:111], v[60:63], a[44:47], v[108:111]
    v_mfma_f32_16x16x32_bf16 v[108:111], v[64:67], a[48:51], v[108:111]
    v_mfma_f32_16x16x32_bf16 v[108:111], v[68:71], a[52:55], v[108:111]
    v_mfma_f32_16x16x32_bf16 v[108:111], v[72:75], a[56:59], v[108:111]
    v_mfma_f32_16x16x32_bf16 v[108:111], v[76:79], a[60:63], v[108:111]
    s_waitcnt lgkmcnt(0)
    s_waitcnt vmcnt(4)
    v_lshlrev_b32 v80, 16, v128
    v_and_b32 v81, 0xffff0000, v128
    v_lshlrev_b32 v82, 16, v129
    v_and_b32 v83, 0xffff0000, v129
    v_lshlrev_b32 v84, 16, v130
    v_and_b32 v85, 0xffff0000, v130
    v_lshlrev_b32 v86, 16, v131
    v_and_b32 v87, 0xffff0000, v131
    v_lshlrev_b32 v88, 16, v132
    v_and_b32 v89, 0xffff0000, v132
    v_lshlrev_b32 v90, 16, v133
    v_and_b32 v91, 0xffff0000, v133
    v_lshlrev_b32 v92, 16, v134
    v_and_b32 v93, 0xffff0000, v134
    v_lshlrev_b32 v94, 16, v135
    v_and_b32 v95, 0xffff0000, v135
    v_pk_mul_f32 v[80:81], v[80:81], s[46:47]
    v_pk_mul_f32 v[82:83], v[82:83], s[46:47]
    v_pk_mul_f32 v[84:85], v[84:85], s[46:47]
    v_pk_mul_f32 v[86:87], v[86:87], s[46:47]
    v_pk_mul_f32 v[88:89], v[88:89], s[46:47]
    v_pk_mul_f32 v[90:91], v[90:91], s[46:47]
    v_pk_mul_f32 v[92:93], v[92:93], s[46:47]
    v_pk_mul_f32 v[94:95], v[94:95], s[46:47]
    v_cvt_pk_bf16_f32 v128, v80, v81
    v_cvt_pk_bf16_f32 v129, v82, v83
    v_cvt_pk_bf16_f32 v130, v84, v85
    v_cvt_pk_bf16_f32 v131, v86, v87
    v_cvt_pk_bf16_f32 v132, v88, v89
    v_cvt_pk_bf16_f32 v133, v90, v91
    v_cvt_pk_bf16_f32 v134, v92, v93
    v_cvt_pk_bf16_f32 v135, v94, v95
    ds_write_b128 v13, v[128:131] offset:16384
    ds_write_b128 v0, v[132:135] offset:16384
    v_lshlrev_b32 v80, 16, v136
    v_and_b32 v81, 0xffff0000, v136
    v_lshlrev_b32 v82, 16, v137
    v_and_b32 v83, 0xffff0000, v137
    v_lshlrev_b32 v84, 16, v138
    v_and_b32 v85, 0xffff0000, v138
    v_lshlrev_b32 v86, 16, v139
    v_and_b32 v87, 0xffff0000, v139
    v_lshlrev_b32 v88, 16, v140
    v_and_b32 v89, 0xffff0000, v140
    v_lshlrev_b32 v90, 16, v141
    v_and_b32 v91, 0xffff0000, v141
    v_lshlrev_b32 v92, 16, v142
    v_and_b32 v93, 0xffff0000, v142
    v_lshlrev_b32 v94, 16, v143
    v_and_b32 v95, 0xffff0000, v143
    v_pk_mul_f32 v[80:81], v[80:81], s[46:47]
    v_pk_mul_f32 v[82:83], v[82:83], s[46:47]
    v_pk_mul_f32 v[84:85], v[84:85], s[46:47]
    v_pk_mul_f32 v[86:87], v[86:87], s[46:47]
    v_pk_mul_f32 v[88:89], v[88:89], s[46:47]
    v_pk_mul_f32 v[90:91], v[90:91], s[46:47]
    v_pk_mul_f32 v[92:93], v[92:93], s[46:47]
    v_pk_mul_f32 v[94:95], v[94:95], s[46:47]
    v_cvt_pk_bf16_f32 v136, v80, v81
    v_cvt_pk_bf16_f32 v137, v82, v83
    v_cvt_pk_bf16_f32 v138, v84, v85
    v_cvt_pk_bf16_f32 v139, v86, v87
    v_cvt_pk_bf16_f32 v140, v88, v89
    v_cvt_pk_bf16_f32 v141, v90, v91
    v_cvt_pk_bf16_f32 v142, v92, v93
    v_cvt_pk_bf16_f32 v143, v94, v95
    ds_write_b128 v13, v[136:139] offset:49152
    ds_write_b128 v0, v[140:143] offset:49152
    s_waitcnt lgkmcnt(0)
    s_barrier
    ds_read_b128 v[128:131], v4 offset:16384
    ds_read_b128 v[132:135], v5 offset:16384
    ds_read_b128 v[136:139], v14 offset:16384
    ds_read_b128 v[140:143], v15 offset:16384
    ds_read_b128 v[144:147], v4 offset:16640
    ds_read_b128 v[148:151], v5 offset:16640
    ds_read_b128 v[152:155], v14 offset:16640
    ds_read_b128 v[156:159], v15 offset:16640
    s_waitcnt lgkmcnt(7)
    v_mfma_f32_16x16x32_bf16 v[112:115], v[16:19], v[128:131], 0
    s_waitcnt lgkmcnt(6)
    v_mfma_f32_16x16x32_bf16 v[112:115], v[20:23], v[132:135], v[112:115]
    s_waitcnt lgkmcnt(5)
    v_mfma_f32_16x16x32_bf16 v[112:115], v[24:27], v[136:139], v[112:115]
    s_waitcnt lgkmcnt(4)
    v_mfma_f32_16x16x32_bf16 v[112:115], v[28:31], v[140:143], v[112:115]
    s_waitcnt lgkmcnt(3)
    v_mfma_f32_16x16x32_bf16 v[112:115], v[32:35], v[144:147], v[112:115]
    s_waitcnt lgkmcnt(2)
    v_mfma_f32_16x16x32_bf16 v[112:115], v[36:39], v[148:151], v[112:115]
    s_waitcnt lgkmcnt(1)
    v_mfma_f32_16x16x32_bf16 v[112:115], v[40:43], v[152:155], v[112:115]
    s_waitcnt lgkmcnt(0)
    v_mfma_f32_16x16x32_bf16 v[112:115], v[44:47], v[156:159], v[112:115]
    v_mfma_f32_16x16x32_bf16 v[116:119], v[48:51], v[128:131], 0
    v_mfma_f32_16x16x32_bf16 v[116:119], v[52:55], v[132:135], v[116:119]
    v_mfma_f32_16x16x32_bf16 v[116:119], v[56:59], v[136:139], v[116:119]
    v_mfma_f32_16x16x32_bf16 v[116:119], v[60:63], v[140:143], v[116:119]
    v_mfma_f32_16x16x32_bf16 v[116:119], v[64:67], v[144:147], v[116:119]
    v_mfma_f32_16x16x32_bf16 v[116:119], v[68:71], v[148:151], v[116:119]
    v_mfma_f32_16x16x32_bf16 v[116:119], v[72:75], v[152:155], v[116:119]
    v_mfma_f32_16x16x32_bf16 v[116:119], v[76:79], v[156:159], v[116:119]
    s_waitcnt lgkmcnt(0)
    s_waitcnt vmcnt(0)
    v_lshlrev_b32 v80, 16, v160
    v_and_b32 v81, 0xffff0000, v160
    v_lshlrev_b32 v82, 16, v161
    v_and_b32 v83, 0xffff0000, v161
    v_lshlrev_b32 v84, 16, v162
    v_and_b32 v85, 0xffff0000, v162
    v_lshlrev_b32 v86, 16, v163
    v_and_b32 v87, 0xffff0000, v163
    v_lshlrev_b32 v88, 16, v164
    v_and_b32 v89, 0xffff0000, v164
    v_lshlrev_b32 v90, 16, v165
    v_and_b32 v91, 0xffff0000, v165
    v_lshlrev_b32 v92, 16, v166
    v_and_b32 v93, 0xffff0000, v166
    v_lshlrev_b32 v94, 16, v167
    v_and_b32 v95, 0xffff0000, v167
    v_pk_mul_f32 v[80:81], v[80:81], s[46:47]
    v_pk_mul_f32 v[82:83], v[82:83], s[46:47]
    v_pk_mul_f32 v[84:85], v[84:85], s[46:47]
    v_pk_mul_f32 v[86:87], v[86:87], s[46:47]
    v_pk_mul_f32 v[88:89], v[88:89], s[46:47]
    v_pk_mul_f32 v[90:91], v[90:91], s[46:47]
    v_pk_mul_f32 v[92:93], v[92:93], s[46:47]
    v_pk_mul_f32 v[94:95], v[94:95], s[46:47]
    v_cvt_pk_bf16_f32 v160, v80, v81
    v_cvt_pk_bf16_f32 v161, v82, v83
    v_cvt_pk_bf16_f32 v162, v84, v85
    v_cvt_pk_bf16_f32 v163, v86, v87
    v_cvt_pk_bf16_f32 v164, v88, v89
    v_cvt_pk_bf16_f32 v165, v90, v91
    v_cvt_pk_bf16_f32 v166, v92, v93
    v_cvt_pk_bf16_f32 v167, v94, v95
    ds_write_b128 v13, v[160:163] offset:24576
    ds_write_b128 v0, v[164:167] offset:24576
    v_lshlrev_b32 v80, 16, v168
    v_and_b32 v81, 0xffff0000, v168
    v_lshlrev_b32 v82, 16, v169
    v_and_b32 v83, 0xffff0000, v169
    v_lshlrev_b32 v84, 16, v170
    v_and_b32 v85, 0xffff0000, v170
    v_lshlrev_b32 v86, 16, v171
    v_and_b32 v87, 0xffff0000, v171
    v_lshlrev_b32 v88, 16, v172
    v_and_b32 v89, 0xffff0000, v172
    v_lshlrev_b32 v90, 16, v173
    v_and_b32 v91, 0xffff0000, v173
    v_lshlrev_b32 v92, 16, v174
    v_and_b32 v93, 0xffff0000, v174
    v_lshlrev_b32 v94, 16, v175
    v_and_b32 v95, 0xffff0000, v175
    v_pk_mul_f32 v[80:81], v[80:81], s[46:47]
    v_pk_mul_f32 v[82:83], v[82:83], s[46:47]
    v_pk_mul_f32 v[84:85], v[84:85], s[46:47]
    v_pk_mul_f32 v[86:87], v[86:87], s[46:47]
    v_pk_mul_f32 v[88:89], v[88:89], s[46:47]
    v_pk_mul_f32 v[90:91], v[90:91], s[46:47]
    v_pk_mul_f32 v[92:93], v[92:93], s[46:47]
    v_pk_mul_f32 v[94:95], v[94:95], s[46:47]
    v_cvt_pk_bf16_f32 v168, v80, v81
    v_cvt_pk_bf16_f32 v169, v82, v83
    v_cvt_pk_bf16_f32 v170, v84, v85
    v_cvt_pk_bf16_f32 v171, v86, v87
    v_cvt_pk_bf16_f32 v172, v88, v89
    v_cvt_pk_bf16_f32 v173, v90, v91
    v_cvt_pk_bf16_f32 v174, v92, v93
    v_cvt_pk_bf16_f32 v175, v94, v95
    ds_write_b128 v13, v[168:171] offset:57344
    ds_write_b128 v0, v[172:175] offset:57344
    s_waitcnt lgkmcnt(0)
    s_barrier
    ds_read_b128 v[160:163], v4 offset:24576
    ds_read_b128 v[164:167], v5 offset:24576
    ds_read_b128 v[168:171], v14 offset:24576
    ds_read_b128 v[172:175], v15 offset:24576
    ds_read_b128 v[176:179], v4 offset:24832
    ds_read_b128 v[180:183], v5 offset:24832
    ds_read_b128 v[184:187], v14 offset:24832
    ds_read_b128 v[188:191], v15 offset:24832
    s_waitcnt lgkmcnt(7)
    v_mfma_f32_16x16x32_bf16 v[120:123], v[16:19], v[160:163], 0
    s_waitcnt lgkmcnt(6)
    v_mfma_f32_16x16x32_bf16 v[120:123], v[20:23], v[164:167], v[120:123]
    s_waitcnt lgkmcnt(5)
    v_mfma_f32_16x16x32_bf16 v[120:123], v[24:27], v[168:171], v[120:123]
    s_waitcnt lgkmcnt(4)
    v_mfma_f32_16x16x32_bf16 v[120:123], v[28:31], v[172:175], v[120:123]
    s_waitcnt lgkmcnt(3)
    v_mfma_f32_16x16x32_bf16 v[120:123], v[32:35], v[176:179], v[120:123]
    s_waitcnt lgkmcnt(2)
    v_mfma_f32_16x16x32_bf16 v[120:123], v[36:39], v[180:183], v[120:123]
    s_waitcnt lgkmcnt(1)
    v_mfma_f32_16x16x32_bf16 v[120:123], v[40:43], v[184:187], v[120:123]
    s_waitcnt lgkmcnt(0)
    v_mfma_f32_16x16x32_bf16 v[120:123], v[44:47], v[188:191], v[120:123]
    v_mfma_f32_16x16x32_bf16 v[124:127], v[48:51], v[160:163], 0
    v_mfma_f32_16x16x32_bf16 v[124:127], v[52:55], v[164:167], v[124:127]
    v_mfma_f32_16x16x32_bf16 v[124:127], v[56:59], v[168:171], v[124:127]
    v_mfma_f32_16x16x32_bf16 v[124:127], v[60:63], v[172:175], v[124:127]
    v_mfma_f32_16x16x32_bf16 v[124:127], v[64:67], v[176:179], v[124:127]
    v_mfma_f32_16x16x32_bf16 v[124:127], v[68:71], v[180:183], v[124:127]
    v_mfma_f32_16x16x32_bf16 v[124:127], v[72:75], v[184:187], v[124:127]
    v_mfma_f32_16x16x32_bf16 v[124:127], v[76:79], v[188:191], v[124:127]
    s_waitcnt lgkmcnt(0)
    s_lshl_b32 s50, s54, 10
    s_add_u32 s50, s50, 147456
    v_lshlrev_b32 v7, 4, v2
    v_add_u32 v13, s50, v7
    s_nop 3
    v_max3_f32 v80, v96, v97, v98
    v_max3_f32 v80, v80, v99, v100
    v_max3_f32 v80, v80, v101, v102
    v_max_f32 v80, v80, v103
    v_max3_f32 v81, v104, v105, v106
    v_max3_f32 v81, v81, v107, v108
    v_max3_f32 v81, v81, v109, v110
    v_max_f32 v81, v81, v111
    v_max3_f32 v82, v112, v113, v114
    v_max3_f32 v82, v82, v115, v116
    v_max3_f32 v82, v82, v117, v118
    v_max_f32 v82, v82, v119
    v_max3_f32 v83, v120, v121, v122
    v_max3_f32 v83, v83, v123, v124
    v_max3_f32 v83, v83, v125, v126
    v_max_f32 v83, v83, v127
    v_mov_b32 v84, v80
    v_mov_b32 v85, v81
    v_mov_b32 v86, v82
    v_mov_b32 v87, v83
    s_nop 1
    v_permlane16_swap_b32 v80, v84
    v_permlane16_swap_b32 v81, v85
    v_permlane16_swap_b32 v82, v86
    v_permlane16_swap_b32 v83, v87
    v_max_f32 v80, v80, v84
    v_max_f32 v81, v81, v85
    v_max_f32 v82, v82, v86
    v_max_f32 v83, v83, v87
    v_mov_b32 v84, v80
    v_mov_b32 v85, v81
    v_mov_b32 v86, v82
    v_mov_b32 v87, v83
    s_nop 1
    v_permlane32_swap_b32 v80, v84
    v_permlane32_swap_b32 v81, v85
    v_permlane32_swap_b32 v82, v86
    v_permlane32_swap_b32 v83, v87
    v_max_f32 v80, v80, v84
    v_max_f32 v81, v81, v85
    v_max_f32 v82, v82, v86
    v_max_f32 v83, v83, v87
    ds_write_b128 v13, v[80:83]
    s_waitcnt lgkmcnt(0)
    s_barrier
    v_xor_b32 v7, 1024, v13
    ds_read_b128 v[84:87], v7
    v_mov_b32 v4, 0
    v_mov_b32 v5, 0
    v_mov_b32 v6, 0
    v_mov_b32 v7, 0
    s_waitcnt lgkmcnt(0)
    v_max_f32 v80, v80, v84
    v_max_f32 v81, v81, v85
    v_max_f32 v82, v82, v86
    v_max_f32 v83, v83, v87
    v_sub_f32 v84, 0, v80
    v_sub_f32 v85, 0, v81
    v_sub_f32 v86, 0, v82
    v_sub_f32 v87, 0, v83
    v_add_f32 v96, v96, v84
    v_add_f32 v97, v97, v84
    v_add_f32 v98, v98, v84
    v_add_f32 v99, v99, v84
    v_exp_f32 v96, v96
    v_exp_f32 v97, v97
    v_exp_f32 v98, v98
    v_exp_f32 v99, v99
    v_add_f32 v4, v4, v96
    v_cvt_pk_bf16_f32 v16, v96, v97
    v_add_f32 v4, v4, v97
    v_cvt_pk_bf16_f32 v17, v98, v99
    v_add_f32 v98, v98, v99
    v_add_f32 v4, v4, v98
    v_add_f32 v100, v100, v84
    v_add_f32 v101, v101, v84
    v_add_f32 v102, v102, v84
    v_add_f32 v103, v103, v84
    v_exp_f32 v100, v100
    v_exp_f32 v101, v101
    v_exp_f32 v102, v102
    v_exp_f32 v103, v103
    v_add_f32 v4, v4, v100
    v_cvt_pk_bf16_f32 v18, v100, v101
    v_add_f32 v4, v4, v101
    v_cvt_pk_bf16_f32 v19, v102, v103
    v_add_f32 v102, v102, v103
    v_add_f32 v4, v4, v102
    v_add_f32 v104, v104, v85
    v_add_f32 v105, v105, v85
    v_add_f32 v106, v106, v85
    v_add_f32 v107, v107, v85
    v_exp_f32 v104, v104
    v_exp_f32 v105, v105
    v_exp_f32 v106, v106
    v_exp_f32 v107, v107
    v_add_f32 v5, v5, v104
    v_cvt_pk_bf16_f32 v20, v104, v105
    v_add_f32 v5, v5, v105
    v_cvt_pk_bf16_f32 v21, v106, v107
    v_add_f32 v106, v106, v107
    v_add_f32 v5, v5, v106
    v_add_f32 v108, v108, v85
    v_add_f32 v109, v109, v85
    v_add_f32 v110, v110, v85
    v_add_f32 v111, v111, v85
    v_exp_f32 v108, v108
    v_exp_f32 v109, v109
    v_exp_f32 v110, v110
    v_exp_f32 v111, v111
    v_add_f32 v5, v5, v108
    v_cvt_pk_bf16_f32 v22, v108, v109
    v_add_f32 v5, v5, v109
    v_cvt_pk_bf16_f32 v23, v110, v111
    v_add_f32 v110, v110, v111
    v_add_f32 v5, v5, v110
    v_add_f32 v112, v112, v86
    v_add_f32 v113, v113, v86
    v_add_f32 v114, v114, v86
    v_add_f32 v115, v115, v86
    v_exp_f32 v112, v112
    v_exp_f32 v113, v113
    v_exp_f32 v114, v114
    v_exp_f32 v115, v115
    v_add_f32 v6, v6, v112
    v_cvt_pk_bf16_f32 v24, v112, v113
    v_add_f32 v6, v6, v113
    v_cvt_pk_bf16_f32 v25, v114, v115
    v_add_f32 v114, v114, v115
    v_add_f32 v6, v6, v114
    v_add_f32 v116, v116, v86
    v_add_f32 v117, v117, v86
    v_add_f32 v118, v118, v86
    v_add_f32 v119, v119, v86
    v_exp_f32 v116, v116
    v_exp_f32 v117, v117
    v_exp_f32 v118, v118
    v_exp_f32 v119, v119
    v_add_f32 v6, v6, v116
    v_cvt_pk_bf16_f32 v26, v116, v117
    v_add_f32 v6, v6, v117
    v_cvt_pk_bf16_f32 v27, v118, v119
    v_add_f32 v118, v118, v119
    v_add_f32 v6, v6, v118
    v_add_f32 v120, v120, v87
    v_add_f32 v121, v121, v87
    v_add_f32 v122, v122, v87
    v_add_f32 v123, v123, v87
    v_exp_f32 v120, v120
    v_exp_f32 v121, v121
    v_exp_f32 v122, v122
    v_exp_f32 v123, v123
    v_add_f32 v7, v7, v120
    v_cvt_pk_bf16_f32 v28, v120, v121
    v_add_f32 v7, v7, v121
    v_cvt_pk_bf16_f32 v29, v122, v123
    v_add_f32 v122, v122, v123
    v_add_f32 v7, v7, v122
    v_add_f32 v124, v124, v87
    v_add_f32 v125, v125, v87
    v_add_f32 v126, v126, v87
    v_add_f32 v127, v127, v87
    v_exp_f32 v124, v124
    v_exp_f32 v125, v125
    v_exp_f32 v126, v126
    v_exp_f32 v127, v127
    v_add_f32 v7, v7, v124
    v_cvt_pk_bf16_f32 v30, v124, v125
    v_add_f32 v7, v7, v125
    v_cvt_pk_bf16_f32 v31, v126, v127
    v_add_f32 v126, v126, v127
    v_add_f32 v7, v7, v126
    v_mov_b32 v112, v16
    v_mov_b32 v113, v17
    v_mov_b32 v114, v18
    v_mov_b32 v115, v19
    v_mov_b32 v116, v20
    v_mov_b32 v117, v21
    v_mov_b32 v118, v22
    v_mov_b32 v119, v23
    v_mov_b32 v120, v24
    v_mov_b32 v121, v25
    v_mov_b32 v122, v26
    v_mov_b32 v123, v27
    v_mov_b32 v124, v28
    v_mov_b32 v125, v29
    v_mov_b32 v126, v30
    v_mov_b32 v127, v31
    v_mov_b32 v96, v84
    v_mov_b32 v97, v84
    v_mov_b32 v98, v84
    v_mov_b32 v99, v84
    v_mov_b32 v100, v85
    v_mov_b32 v101, v85
    v_mov_b32 v102, v85
    v_mov_b32 v103, v85
    v_mov_b32 v104, v86
    v_mov_b32 v105, v86
    v_mov_b32 v106, v86
    v_mov_b32 v107, v86
    v_mov_b32 v108, v87
    v_mov_b32 v109, v87
    v_mov_b32 v110, v87
    v_mov_b32 v111, v87
L_qk_main:
    s_barrier
    s_mov_b32 s40, 15
.p2align 6
L_qk_loop:
    s_setprio 3
    ds_read_b128 v[16:19], v8 offset:32768
    ds_read_b128 v[20:23], v9 offset:32768
    ds_read_b128 v[24:27], v10 offset:32768
    ds_read_b128 v[28:31], v11 offset:32768
    ds_read_b128 v[32:35], v8 offset:33024
    ds_read_b128 v[36:39], v9 offset:33024
    ds_read_b128 v[40:43], v10 offset:33024
    ds_read_b128 v[44:47], v11 offset:33024
    ds_write_b128 v12, v[112:115] offset:0
    ds_write_b128 v12, v[116:119] offset:1024
    ds_write_b128 v12, v[120:123] offset:2048
    ds_write_b128 v12, v[124:127] offset:3072
    s_setprio 2
    s_waitcnt lgkmcnt(4)
    v_mfma_f32_16x16x32_bf16 v[80:83], v[16:19], a[0:3], v[96:99]
    v_mfma_f32_16x16x32_bf16 v[80:83], v[20:23], a[4:7], v[80:83]
    v_mfma_f32_16x16x32_bf16 v[80:83], v[24:27], a[8:11], v[80:83]
    ds_read_b128 v[48:51], v8 offset:40960
    v_mfma_f32_16x16x32_bf16 v[80:83], v[28:31], a[12:15], v[80:83]
    ds_read_b128 v[52:55], v9 offset:40960
    v_mfma_f32_16x16x32_bf16 v[80:83], v[32:35], a[16:19], v[80:83]
    ds_read_b128 v[56:59], v10 offset:40960
    v_mfma_f32_16x16x32_bf16 v[80:83], v[36:39], a[20:23], v[80:83]
    ds_read_b128 v[60:63], v11 offset:40960
    v_mfma_f32_16x16x32_bf16 v[80:83], v[40:43], a[24:27], v[80:83]
    ds_read_b128 v[64:67], v8 offset:41216
    v_mfma_f32_16x16x32_bf16 v[80:83], v[44:47], a[28:31], v[80:83]
    ds_read_b128 v[68:71], v9 offset:41216
    s_waitcnt lgkmcnt(6)
    v_mfma_f32_16x16x32_bf16 v[84:87], v[16:19], a[32:35], v[100:103]
    ds_read_b128 v[72:75], v10 offset:41216
    ds_read_b128 v[76:79], v11 offset:41216
    v_mfma_f32_16x16x32_bf16 v[84:87], v[20:23], a[36:39], v[84:87]
    v_mfma_f32_16x16x32_bf16 v[84:87], v[24:27], a[40:43], v[84:87]
    v_mfma_f32_16x16x32_bf16 v[84:87], v[28:31], a[44:47], v[84:87]
    v_mfma_f32_16x16x32_bf16 v[84:87], v[32:35], a[48:51], v[84:87]
    v_mfma_f32_16x16x32_bf16 v[84:87], v[36:39], a[52:55], v[84:87]
    v_exp_f32 v80, v80
    v_mfma_f32_16x16x32_bf16 v[84:87], v[40:43], a[56:59], v[84:87]
    v_exp_f32 v81, v81
    v_mfma_f32_16x16x32_bf16 v[84:87], v[44:47], a[60:63], v[84:87]
    v_exp_f32 v82, v82
    v_mfma_f32_16x16x32_bf16 v[88:91], v[16:19], v[128:131], v[104:107]
    v_exp_f32 v83, v83
    v_mfma_f32_16x16x32_bf16 v[88:91], v[20:23], v[132:135], v[88:91]
    v_add_f32 v4, v4, v80
    v_cvt_pk_bf16_f32 v112, v80, v81
    v_mfma_f32_16x16x32_bf16 v[88:91], v[24:27], v[136:139], v[88:91]
    v_add_f32 v4, v4, v81
    v_cvt_pk_bf16_f32 v113, v82, v83
    v_mfma_f32_16x16x32_bf16 v[88:91], v[28:31], v[140:143], v[88:91]
    v_add_f32 v82, v82, v83
    v_add_f32 v4, v4, v82
    v_mfma_f32_16x16x32_bf16 v[88:91], v[32:35], v[144:147], v[88:91]
    v_exp_f32 v84, v84
    v_mfma_f32_16x16x32_bf16 v[88:91], v[36:39], v[148:151], v[88:91]
    v_exp_f32 v85, v85
    v_mfma_f32_16x16x32_bf16 v[88:91], v[40:43], v[152:155], v[88:91]
    v_exp_f32 v86, v86
    v_mfma_f32_16x16x32_bf16 v[88:91], v[44:47], v[156:159], v[88:91]
    v_exp_f32 v87, v87
    s_waitcnt lgkmcnt(0)
    s_barrier
    v_mfma_f32_16x16x32_bf16 v[92:95], v[16:19], v[160:163], v[108:111]
    v_add_f32 v5, v5, v84
    v_cvt_pk_bf16_f32 v116, v84, v85
    v_mfma_f32_16x16x32_bf16 v[92:95], v[20:23], v[164:167], v[92:95]
    v_add_f32 v5, v5, v85
    v_cvt_pk_bf16_f32 v117, v86, v87
    v_mfma_f32_16x16x32_bf16 v[92:95], v[24:27], v[168:171], v[92:95]
    v_add_f32 v86, v86, v87
    v_add_f32 v5, v5, v86
    v_mfma_f32_16x16x32_bf16 v[92:95], v[28:31], v[172:175], v[92:95]
    v_exp_f32 v88, v88
    v_mfma_f32_16x16x32_bf16 v[92:95], v[32:35], v[176:179], v[92:95]
    v_exp_f32 v89, v89
    v_mfma_f32_16x16x32_bf16 v[92:95], v[36:39], v[180:183], v[92:95]
    v_exp_f32 v90, v90
    v_mfma_f32_16x16x32_bf16 v[92:95], v[40:43], v[184:187], v[92:95]
    v_exp_f32 v91, v91
    v_mfma_f32_16x16x32_bf16 v[92:95], v[44:47], v[188:191], v[92:95]
    v_add_f32 v6, v6, v88
    v_cvt_pk_bf16_f32 v120, v88, v89
    v_mfma_f32_16x16x32_bf16 v[80:83], v[48:51], a[0:3], v[96:99]
    v_add_f32 v6, v6, v89
    v_cvt_pk_bf16_f32 v121, v90, v91
    v_mfma_f32_16x16x32_bf16 v[80:83], v[52:55], a[4:7], v[80:83]
    v_add_f32 v90, v90, v91
    v_add_f32 v6, v6, v90
    v_mfma_f32_16x16x32_bf16 v[80:83], v[56:59], a[8:11], v[80:83]
    v_mfma_f32_16x16x32_bf16 v[80:83], v[60:63], a[12:15], v[80:83]
    v_mfma_f32_16x16x32_bf16 v[80:83], v[64:67], a[16:19], v[80:83]
    v_exp_f32 v92, v92
    v_mfma_f32_16x16x32_bf16 v[80:83], v[68:71], a[20:23], v[80:83]
    v_exp_f32 v93, v93
    v_mfma_f32_16x16x32_bf16 v[80:83], v[72:75], a[24:27], v[80:83]
    v_exp_f32 v94, v94
    v_mfma_f32_16x16x32_bf16 v[80:83], v[76:79], a[28:31], v[80:83]
    v_exp_f32 v95, v95
    v_mfma_f32_16x16x32_bf16 v[84:87], v[48:51], a[32:35], v[100:103]
    v_add_f32 v7, v7, v92
    v_cvt_pk_bf16_f32 v124, v92, v93
    v_mfma_f32_16x16x32_bf16 v[84:87], v[52:55], a[36:39], v[84:87]
    v_add_f32 v7, v7, v93
    v_cvt_pk_bf16_f32 v125, v94, v95
    v_mfma_f32_16x16x32_bf16 v[84:87], v[56:59], a[40:43], v[84:87]
    v_add_f32 v94, v94, v95
    v_add_f32 v7, v7, v94
    v_mfma_f32_16x16x32_bf16 v[84:87], v[60:63], a[44:47], v[84:87]
    v_exp_f32 v80, v80
    v_mfma_f32_16x16x32_bf16 v[84:87], v[64:67], a[48:51], v[84:87]
    v_exp_f32 v81, v81
    v_mfma_f32_16x16x32_bf16 v[84:87], v[68:71], a[52:55], v[84:87]
    v_exp_f32 v82, v82
    v_mfma_f32_16x16x32_bf16 v[84:87], v[72:75], a[56:59], v[84:87]
    v_exp_f32 v83, v83
    v_mfma_f32_16x16x32_bf16 v[84:87], v[76:79], a[60:63], v[84:87]
    v_add_f32 v4, v4, v80
    v_cvt_pk_bf16_f32 v114, v80, v81
    v_mfma_f32_16x16x32_bf16 v[88:91], v[48:51], v[128:131], v[104:107]
    v_add_f32 v4, v4, v81
    v_cvt_pk_bf16_f32 v115, v82, v83
    v_mfma_f32_16x16x32_bf16 v[88:91], v[52:55], v[132:135], v[88:91]
    v_add_f32 v82, v82, v83
    v_add_f32 v4, v4, v82
    v_mfma_f32_16x16x32_bf16 v[88:91], v[56:59], v[136:139], v[88:91]
    v_mfma_f32_16x16x32_bf16 v[88:91], v[60:63], v[140:143], v[88:91]
    v_mfma_f32_16x16x32_bf16 v[88:91], v[64:67], v[144:147], v[88:91]
    v_exp_f32 v84, v84
    v_mfma_f32_16x16x32_bf16 v[88:91], v[68:71], v[148:151], v[88:91]
    v_exp_f32 v85, v85
    v_mfma_f32_16x16x32_bf16 v[88:91], v[72:75], v[152:155], v[88:91]
    v_exp_f32 v86, v86
    v_mfma_f32_16x16x32_bf16 v[88:91], v[76:79], v[156:159], v[88:91]
    v_exp_f32 v87, v87
    v_mfma_f32_16x16x32_bf16 v[92:95], v[48:51], v[160:163], v[108:111]
    v_add_f32 v5, v5, v84
    v_cvt_pk_bf16_f32 v118, v84, v85
    v_mfma_f32_16x16x32_bf16 v[92:95], v[52:55], v[164:167], v[92:95]
    v_add_f32 v5, v5, v85
    v_cvt_pk_bf16_f32 v119, v86, v87
    v_mfma_f32_16x16x32_bf16 v[92:95], v[56:59], v[168:171], v[92:95]
    v_add_f32 v86, v86, v87
    v_add_f32 v5, v5, v86
    v_mfma_f32_16x16x32_bf16 v[92:95], v[60:63], v[172:175], v[92:95]
    v_exp_f32 v88, v88
    v_mfma_f32_16x16x32_bf16 v[92:95], v[64:67], v[176:179], v[92:95]
    v_exp_f32 v89, v89
    v_mfma_f32_16x16x32_bf16 v[92:95], v[68:71], v[180:183], v[92:95]
    v_exp_f32 v90, v90
    v_mfma_f32_16x16x32_bf16 v[92:95], v[72:75], v[184:187], v[92:95]
    v_exp_f32 v91, v91
    v_mfma_f32_16x16x32_bf16 v[92:95], v[76:79], v[188:191], v[92:95]
    v_add_f32 v6, v6, v88
    v_cvt_pk_bf16_f32 v122, v88, v89
    s_setprio 0
    v_add_f32 v6, v6, v89
    v_cvt_pk_bf16_f32 v123, v90, v91
    v_add_f32 v90, v90, v91
    v_add_f32 v6, v6, v90
    s_nop 3
    v_exp_f32 v92, v92
    v_exp_f32 v93, v93
    v_exp_f32 v94, v94
    v_exp_f32 v95, v95
    v_add_f32 v7, v7, v92
    v_cvt_pk_bf16_f32 v126, v92, v93
    v_add_f32 v7, v7, v93
    v_cvt_pk_bf16_f32 v127, v94, v95
    v_add_f32 v94, v94, v95
    v_add_f32 v7, v7, v94
    s_barrier
    s_setprio 3
    ds_read_b128 v[16:19], v8 offset:0
    ds_read_b128 v[20:23], v9 offset:0
    ds_read_b128 v[24:27], v10 offset:0
    ds_read_b128 v[28:31], v11 offset:0
    ds_read_b128 v[32:35], v8 offset:256
    ds_read_b128 v[36:39], v9 offset:256
    ds_read_b128 v[40:43], v10 offset:256
    ds_read_b128 v[44:47], v11 offset:256
    ds_write_b128 v12, v[112:115] offset:0
    ds_write_b128 v12, v[116:119] offset:1024
    ds_write_b128 v12, v[120:123] offset:2048
    ds_write_b128 v12, v[124:127] offset:3072
    s_setprio 2
    s_waitcnt lgkmcnt(4)
    v_mfma_f32_16x16x32_bf16 v[80:83], v[16:19], a[0:3], v[96:99]
    v_mfma_f32_16x16x32_bf16 v[80:83], v[20:23], a[4:7], v[80:83]
    v_mfma_f32_16x16x32_bf16 v[80:83], v[24:27], a[8:11], v[80:83]
    ds_read_b128 v[48:51], v8 offset:8192
    v_mfma_f32_16x16x32_bf16 v[80:83], v[28:31], a[12:15], v[80:83]
    ds_read_b128 v[52:55], v9 offset:8192
    v_mfma_f32_16x16x32_bf16 v[80:83], v[32:35], a[16:19], v[80:83]
    ds_read_b128 v[56:59], v10 offset:8192
    v_mfma_f32_16x16x32_bf16 v[80:83], v[36:39], a[20:23], v[80:83]
    ds_read_b128 v[60:63], v11 offset:8192
    v_mfma_f32_16x16x32_bf16 v[80:83], v[40:43], a[24:27], v[80:83]
    ds_read_b128 v[64:67], v8 offset:8448
    v_mfma_f32_16x16x32_bf16 v[80:83], v[44:47], a[28:31], v[80:83]
    ds_read_b128 v[68:71], v9 offset:8448
    s_waitcnt lgkmcnt(6)
    v_mfma_f32_16x16x32_bf16 v[84:87], v[16:19], a[32:35], v[100:103]
    ds_read_b128 v[72:75], v10 offset:8448
    ds_read_b128 v[76:79], v11 offset:8448
    v_mfma_f32_16x16x32_bf16 v[84:87], v[20:23], a[36:39], v[84:87]
    v_mfma_f32_16x16x32_bf16 v[84:87], v[24:27], a[40:43], v[84:87]
    v_mfma_f32_16x16x32_bf16 v[84:87], v[28:31], a[44:47], v[84:87]
    v_mfma_f32_16x16x32_bf16 v[84:87], v[32:35], a[48:51], v[84:87]
    v_mfma_f32_16x16x32_bf16 v[84:87], v[36:39], a[52:55], v[84:87]
    v_exp_f32 v80, v80
    v_mfma_f32_16x16x32_bf16 v[84:87], v[40:43], a[56:59], v[84:87]
    v_exp_f32 v81, v81
    v_mfma_f32_16x16x32_bf16 v[84:87], v[44:47], a[60:63], v[84:87]
    v_exp_f32 v82, v82
    v_mfma_f32_16x16x32_bf16 v[88:91], v[16:19], v[128:131], v[104:107]
    v_exp_f32 v83, v83
    v_mfma_f32_16x16x32_bf16 v[88:91], v[20:23], v[132:135], v[88:91]
    v_add_f32 v4, v4, v80
    v_cvt_pk_bf16_f32 v112, v80, v81
    v_mfma_f32_16x16x32_bf16 v[88:91], v[24:27], v[136:139], v[88:91]
    v_add_f32 v4, v4, v81
    v_cvt_pk_bf16_f32 v113, v82, v83
    v_mfma_f32_16x16x32_bf16 v[88:91], v[28:31], v[140:143], v[88:91]
    v_add_f32 v82, v82, v83
    v_add_f32 v4, v4, v82
    v_mfma_f32_16x16x32_bf16 v[88:91], v[32:35], v[144:147], v[88:91]
    v_exp_f32 v84, v84
    v_mfma_f32_16x16x32_bf16 v[88:91], v[36:39], v[148:151], v[88:91]
    v_exp_f32 v85, v85
    v_mfma_f32_16x16x32_bf16 v[88:91], v[40:43], v[152:155], v[88:91]
    v_exp_f32 v86, v86
    v_mfma_f32_16x16x32_bf16 v[88:91], v[44:47], v[156:159], v[88:91]
    v_exp_f32 v87, v87
    s_waitcnt lgkmcnt(0)
    s_barrier
    v_mfma_f32_16x16x32_bf16 v[92:95], v[16:19], v[160:163], v[108:111]
    v_add_f32 v5, v5, v84
    v_cvt_pk_bf16_f32 v116, v84, v85
    v_mfma_f32_16x16x32_bf16 v[92:95], v[20:23], v[164:167], v[92:95]
    v_add_f32 v5, v5, v85
    v_cvt_pk_bf16_f32 v117, v86, v87
    v_mfma_f32_16x16x32_bf16 v[92:95], v[24:27], v[168:171], v[92:95]
    v_add_f32 v86, v86, v87
    v_add_f32 v5, v5, v86
    v_mfma_f32_16x16x32_bf16 v[92:95], v[28:31], v[172:175], v[92:95]
    v_exp_f32 v88, v88
    v_mfma_f32_16x16x32_bf16 v[92:95], v[32:35], v[176:179], v[92:95]
    v_exp_f32 v89, v89
    v_mfma_f32_16x16x32_bf16 v[92:95], v[36:39], v[180:183], v[92:95]
    v_exp_f32 v90, v90
    v_mfma_f32_16x16x32_bf16 v[92:95], v[40:43], v[184:187], v[92:95]
    v_exp_f32 v91, v91
    v_mfma_f32_16x16x32_bf16 v[92:95], v[44:47], v[188:191], v[92:95]
    v_add_f32 v6, v6, v88
    v_cvt_pk_bf16_f32 v120, v88, v89
    v_mfma_f32_16x16x32_bf16 v[80:83], v[48:51], a[0:3], v[96:99]
    v_add_f32 v6, v6, v89
    v_cvt_pk_bf16_f32 v121, v90, v91
    v_mfma_f32_16x16x32_bf16 v[80:83], v[52:55], a[4:7], v[80:83]
    v_add_f32 v90, v90, v91
    v_add_f32 v6, v6, v90
    v_mfma_f32_16x16x32_bf16 v[80:83], v[56:59], a[8:11], v[80:83]
    v_mfma_f32_16x16x32_bf16 v[80:83], v[60:63], a[12:15], v[80:83]
    v_mfma_f32_16x16x32_bf16 v[80:83], v[64:67], a[16:19], v[80:83]
    v_exp_f32 v92, v92
    v_mfma_f32_16x16x32_bf16 v[80:83], v[68:71], a[20:23], v[80:83]
    v_exp_f32 v93, v93
    v_mfma_f32_16x16x32_bf16 v[80:83], v[72:75], a[24:27], v[80:83]
    v_exp_f32 v94, v94
    v_mfma_f32_16x16x32_bf16 v[80:83], v[76:79], a[28:31], v[80:83]
    v_exp_f32 v95, v95
    v_mfma_f32_16x16x32_bf16 v[84:87], v[48:51], a[32:35], v[100:103]
    v_add_f32 v7, v7, v92
    v_cvt_pk_bf16_f32 v124, v92, v93
    v_mfma_f32_16x16x32_bf16 v[84:87], v[52:55], a[36:39], v[84:87]
    v_add_f32 v7, v7, v93
    v_cvt_pk_bf16_f32 v125, v94, v95
    v_mfma_f32_16x16x32_bf16 v[84:87], v[56:59], a[40:43], v[84:87]
    v_add_f32 v94, v94, v95
    v_add_f32 v7, v7, v94
    v_mfma_f32_16x16x32_bf16 v[84:87], v[60:63], a[44:47], v[84:87]
    v_exp_f32 v80, v80
    v_mfma_f32_16x16x32_bf16 v[84:87], v[64:67], a[48:51], v[84:87]
    v_exp_f32 v81, v81
    v_mfma_f32_16x16x32_bf16 v[84:87], v[68:71], a[52:55], v[84:87]
    v_exp_f32 v82, v82
    v_mfma_f32_16x16x32_bf16 v[84:87], v[72:75], a[56:59], v[84:87]
    v_exp_f32 v83, v83
    v_mfma_f32_16x16x32_bf16 v[84:87], v[76:79], a[60:63], v[84:87]
    v_add_f32 v4, v4, v80
    v_cvt_pk_bf16_f32 v114, v80, v81
    v_mfma_f32_16x16x32_bf16 v[88:91], v[48:51], v[128:131], v[104:107]
    v_add_f32 v4, v4, v81
    v_cvt_pk_bf16_f32 v115, v82, v83
    v_mfma_f32_16x16x32_bf16 v[88:91], v[52:55], v[132:135], v[88:91]
    v_add_f32 v82, v82, v83
    v_add_f32 v4, v4, v82
    v_mfma_f32_16x16x32_bf16 v[88:91], v[56:59], v[136:139], v[88:91]
    v_mfma_f32_16x16x32_bf16 v[88:91], v[60:63], v[140:143], v[88:91]
    v_mfma_f32_16x16x32_bf16 v[88:91], v[64:67], v[144:147], v[88:91]
    v_exp_f32 v84, v84
    v_mfma_f32_16x16x32_bf16 v[88:91], v[68:71], v[148:151], v[88:91]
    v_exp_f32 v85, v85
    v_mfma_f32_16x16x32_bf16 v[88:91], v[72:75], v[152:155], v[88:91]
    v_exp_f32 v86, v86
    v_mfma_f32_16x16x32_bf16 v[88:91], v[76:79], v[156:159], v[88:91]
    v_exp_f32 v87, v87
    v_mfma_f32_16x16x32_bf16 v[92:95], v[48:51], v[160:163], v[108:111]
    v_add_f32 v5, v5, v84
    v_cvt_pk_bf16_f32 v118, v84, v85
    v_mfma_f32_16x16x32_bf16 v[92:95], v[52:55], v[164:167], v[92:95]
    v_add_f32 v5, v5, v85
    v_cvt_pk_bf16_f32 v119, v86, v87
    v_mfma_f32_16x16x32_bf16 v[92:95], v[56:59], v[168:171], v[92:95]
    v_add_f32 v86, v86, v87
    v_add_f32 v5, v5, v86
    v_mfma_f32_16x16x32_bf16 v[92:95], v[60:63], v[172:175], v[92:95]
    v_exp_f32 v88, v88
    v_mfma_f32_16x16x32_bf16 v[92:95], v[64:67], v[176:179], v[92:95]
    v_exp_f32 v89, v89
    v_mfma_f32_16x16x32_bf16 v[92:95], v[68:71], v[180:183], v[92:95]
    v_exp_f32 v90, v90
    v_mfma_f32_16x16x32_bf16 v[92:95], v[72:75], v[184:187], v[92:95]
    v_exp_f32 v91, v91
    v_mfma_f32_16x16x32_bf16 v[92:95], v[76:79], v[188:191], v[92:95]
    v_add_f32 v6, v6, v88
    v_cvt_pk_bf16_f32 v122, v88, v89
    s_setprio 0
    v_add_f32 v6, v6, v89
    v_cvt_pk_bf16_f32 v123, v90, v91
    v_add_f32 v90, v90, v91
    v_add_f32 v6, v6, v90
    s_nop 3
    v_exp_f32 v92, v92
    v_exp_f32 v93, v93
    v_exp_f32 v94, v94
    v_exp_f32 v95, v95
    v_add_f32 v7, v7, v92
    v_cvt_pk_bf16_f32 v126, v92, v93
    v_add_f32 v7, v7, v93
    v_cvt_pk_bf16_f32 v127, v94, v95
    v_add_f32 v94, v94, v95
    v_add_f32 v7, v7, v94
    s_barrier
    s_sub_u32 s40, s40, 1
    s_cmp_lg_u32 s40, 0
    s_cbranch_scc1 L_qk_loop
    s_setprio 3
    ds_read_b128 v[16:19], v8 offset:32768
    ds_read_b128 v[20:23], v9 offset:32768
    ds_read_b128 v[24:27], v10 offset:32768
    ds_read_b128 v[28:31], v11 offset:32768
    ds_read_b128 v[32:35], v8 offset:33024
    ds_read_b128 v[36:39], v9 offset:33024
    ds_read_b128 v[40:43], v10 offset:33024
    ds_read_b128 v[44:47], v11 offset:33024
    ds_write_b128 v12, v[112:115] offset:0
    ds_write_b128 v12, v[116:119] offset:1024
    ds_write_b128 v12, v[120:123] offset:2048
    ds_write_b128 v12, v[124:127] offset:3072
    s_setprio 2
    s_waitcnt lgkmcnt(4)
    v_mfma_f32_16x16x32_bf16 v[80:83], v[16:19], a[0:3], v[96:99]
    v_mfma_f32_16x16x32_bf16 v[80:83], v[20:23], a[4:7], v[80:83]
    v_mfma_f32_16x16x32_bf16 v[80:83], v[24:27], a[8:11], v[80:83]
    ds_read_b128 v[48:51], v8 offset:40960
    v_mfma_f32_16x16x32_bf16 v[80:83], v[28:31], a[12:15], v[80:83]
    ds_read_b128 v[52:55], v9 offset:40960
    v_mfma_f32_16x16x32_bf16 v[80:83], v[32:35], a[16:19], v[80:83]
    ds_read_b128 v[56:59], v10 offset:40960
    v_mfma_f32_16x16x32_bf16 v[80:83], v[36:39], a[20:23], v[80:83]
    ds_read_b128 v[60:63], v11 offset:40960
    v_mfma_f32_16x16x32_bf16 v[80:83], v[40:43], a[24:27], v[80:83]
    ds_read_b128 v[64:67], v8 offset:41216
    v_mfma_f32_16x16x32_bf16 v[80:83], v[44:47], a[28:31], v[80:83]
    ds_read_b128 v[68:71], v9 offset:41216
    s_waitcnt lgkmcnt(6)
    v_mfma_f32_16x16x32_bf16 v[84:87], v[16:19], a[32:35], v[100:103]
    ds_read_b128 v[72:75], v10 offset:41216
    ds_read_b128 v[76:79], v11 offset:41216
    v_mfma_f32_16x16x32_bf16 v[84:87], v[20:23], a[36:39], v[84:87]
    v_mfma_f32_16x16x32_bf16 v[84:87], v[24:27], a[40:43], v[84:87]
    v_mfma_f32_16x16x32_bf16 v[84:87], v[28:31], a[44:47], v[84:87]
    v_mfma_f32_16x16x32_bf16 v[84:87], v[32:35], a[48:51], v[84:87]
    v_mfma_f32_16x16x32_bf16 v[84:87], v[36:39], a[52:55], v[84:87]
    v_exp_f32 v80, v80
    v_mfma_f32_16x16x32_bf16 v[84:87], v[40:43], a[56:59], v[84:87]
    v_exp_f32 v81, v81
    v_mfma_f32_16x16x32_bf16 v[84:87], v[44:47], a[60:63], v[84:87]
    v_exp_f32 v82, v82
    v_mfma_f32_16x16x32_bf16 v[88:91], v[16:19], v[128:131], v[104:107]
    v_exp_f32 v83, v83
    v_mfma_f32_16x16x32_bf16 v[88:91], v[20:23], v[132:135], v[88:91]
    v_add_f32 v4, v4, v80
    v_cvt_pk_bf16_f32 v112, v80, v81
    v_mfma_f32_16x16x32_bf16 v[88:91], v[24:27], v[136:139], v[88:91]
    v_add_f32 v4, v4, v81
    v_cvt_pk_bf16_f32 v113, v82, v83
    v_mfma_f32_16x16x32_bf16 v[88:91], v[28:31], v[140:143], v[88:91]
    v_add_f32 v82, v82, v83
    v_add_f32 v4, v4, v82
    v_mfma_f32_16x16x32_bf16 v[88:91], v[32:35], v[144:147], v[88:91]
    v_exp_f32 v84, v84
    v_mfma_f32_16x16x32_bf16 v[88:91], v[36:39], v[148:151], v[88:91]
    v_exp_f32 v85, v85
    v_mfma_f32_16x16x32_bf16 v[88:91], v[40:43], v[152:155], v[88:91]
    v_exp_f32 v86, v86
    v_mfma_f32_16x16x32_bf16 v[88:91], v[44:47], v[156:159], v[88:91]
    v_exp_f32 v87, v87
    s_waitcnt lgkmcnt(0)
    s_barrier
    v_mfma_f32_16x16x32_bf16 v[92:95], v[16:19], v[160:163], v[108:111]
    v_add_f32 v5, v5, v84
    v_cvt_pk_bf16_f32 v116, v84, v85
    v_mfma_f32_16x16x32_bf16 v[92:95], v[20:23], v[164:167], v[92:95]
    v_add_f32 v5, v5, v85
    v_cvt_pk_bf16_f32 v117, v86, v87
    v_mfma_f32_16x16x32_bf16 v[92:95], v[24:27], v[168:171], v[92:95]
    v_add_f32 v86, v86, v87
    v_add_f32 v5, v5, v86
    v_mfma_f32_16x16x32_bf16 v[92:95], v[28:31], v[172:175], v[92:95]
    v_exp_f32 v88, v88
    v_mfma_f32_16x16x32_bf16 v[92:95], v[32:35], v[176:179], v[92:95]
    v_exp_f32 v89, v89
    v_mfma_f32_16x16x32_bf16 v[92:95], v[36:39], v[180:183], v[92:95]
    v_exp_f32 v90, v90
    v_mfma_f32_16x16x32_bf16 v[92:95], v[40:43], v[184:187], v[92:95]
    v_exp_f32 v91, v91
    v_mfma_f32_16x16x32_bf16 v[92:95], v[44:47], v[188:191], v[92:95]
    v_add_f32 v6, v6, v88
    v_cvt_pk_bf16_f32 v120, v88, v89
    v_mfma_f32_16x16x32_bf16 v[80:83], v[48:51], a[0:3], v[96:99]
    v_add_f32 v6, v6, v89
    v_cvt_pk_bf16_f32 v121, v90, v91
    v_mfma_f32_16x16x32_bf16 v[80:83], v[52:55], a[4:7], v[80:83]
    v_add_f32 v90, v90, v91
    v_add_f32 v6, v6, v90
    v_mfma_f32_16x16x32_bf16 v[80:83], v[56:59], a[8:11], v[80:83]
    v_mfma_f32_16x16x32_bf16 v[80:83], v[60:63], a[12:15], v[80:83]
    v_mfma_f32_16x16x32_bf16 v[80:83], v[64:67], a[16:19], v[80:83]
    v_exp_f32 v92, v92
    v_mfma_f32_16x16x32_bf16 v[80:83], v[68:71], a[20:23], v[80:83]
    v_exp_f32 v93, v93
    v_mfma_f32_16x16x32_bf16 v[80:83], v[72:75], a[24:27], v[80:83]
    v_exp_f32 v94, v94
    v_mfma_f32_16x16x32_bf16 v[80:83], v[76:79], a[28:31], v[80:83]
    v_exp_f32 v95, v95
    v_mfma_f32_16x16x32_bf16 v[84:87], v[48:51], a[32:35], v[100:103]
    v_add_f32 v7, v7, v92
    v_cvt_pk_bf16_f32 v124, v92, v93
    v_mfma_f32_16x16x32_bf16 v[84:87], v[52:55], a[36:39], v[84:87]
    v_add_f32 v7, v7, v93
    v_cvt_pk_bf16_f32 v125, v94, v95
    v_mfma_f32_16x16x32_bf16 v[84:87], v[56:59], a[40:43], v[84:87]
    v_add_f32 v94, v94, v95
    v_add_f32 v7, v7, v94
    v_mfma_f32_16x16x32_bf16 v[84:87], v[60:63], a[44:47], v[84:87]
    v_exp_f32 v80, v80
    v_mfma_f32_16x16x32_bf16 v[84:87], v[64:67], a[48:51], v[84:87]
    v_exp_f32 v81, v81
    v_mfma_f32_16x16x32_bf16 v[84:87], v[68:71], a[52:55], v[84:87]
    v_exp_f32 v82, v82
    v_mfma_f32_16x16x32_bf16 v[84:87], v[72:75], a[56:59], v[84:87]
    v_exp_f32 v83, v83
    v_mfma_f32_16x16x32_bf16 v[84:87], v[76:79], a[60:63], v[84:87]
    v_add_f32 v4, v4, v80
    v_cvt_pk_bf16_f32 v114, v80, v81
    v_mfma_f32_16x16x32_bf16 v[88:91], v[48:51], v[128:131], v[104:107]
    v_add_f32 v4, v4, v81
    v_cvt_pk_bf16_f32 v115, v82, v83
    v_mfma_f32_16x16x32_bf16 v[88:91], v[52:55], v[132:135], v[88:91]
    v_add_f32 v82, v82, v83
    v_add_f32 v4, v4, v82
    v_mfma_f32_16x16x32_bf16 v[88:91], v[56:59], v[136:139], v[88:91]
    v_mfma_f32_16x16x32_bf16 v[88:91], v[60:63], v[140:143], v[88:91]
    v_mfma_f32_16x16x32_bf16 v[88:91], v[64:67], v[144:147], v[88:91]
    v_exp_f32 v84, v84
    v_mfma_f32_16x16x32_bf16 v[88:91], v[68:71], v[148:151], v[88:91]
    v_exp_f32 v85, v85
    v_mfma_f32_16x16x32_bf16 v[88:91], v[72:75], v[152:155], v[88:91]
    v_exp_f32 v86, v86
    v_mfma_f32_16x16x32_bf16 v[88:91], v[76:79], v[156:159], v[88:91]
    v_exp_f32 v87, v87
    v_mfma_f32_16x16x32_bf16 v[92:95], v[48:51], v[160:163], v[108:111]
    v_add_f32 v5, v5, v84
    v_cvt_pk_bf16_f32 v118, v84, v85
    v_mfma_f32_16x16x32_bf16 v[92:95], v[52:55], v[164:167], v[92:95]
    v_add_f32 v5, v5, v85
    v_cvt_pk_bf16_f32 v119, v86, v87
    v_mfma_f32_16x16x32_bf16 v[92:95], v[56:59], v[168:171], v[92:95]
    v_add_f32 v86, v86, v87
    v_add_f32 v5, v5, v86
    v_mfma_f32_16x16x32_bf16 v[92:95], v[60:63], v[172:175], v[92:95]
    v_exp_f32 v88, v88
    v_mfma_f32_16x16x32_bf16 v[92:95], v[64:67], v[176:179], v[92:95]
    v_exp_f32 v89, v89
    v_mfma_f32_16x16x32_bf16 v[92:95], v[68:71], v[180:183], v[92:95]
    v_exp_f32 v90, v90
    v_mfma_f32_16x16x32_bf16 v[92:95], v[72:75], v[184:187], v[92:95]
    v_exp_f32 v91, v91
    v_mfma_f32_16x16x32_bf16 v[92:95], v[76:79], v[188:191], v[92:95]
    v_add_f32 v6, v6, v88
    v_cvt_pk_bf16_f32 v122, v88, v89
    s_setprio 0
    v_add_f32 v6, v6, v89
    v_cvt_pk_bf16_f32 v123, v90, v91
    v_add_f32 v90, v90, v91
    v_add_f32 v6, v6, v90
    s_nop 3
    v_exp_f32 v92, v92
    v_exp_f32 v93, v93
    v_exp_f32 v94, v94
    v_exp_f32 v95, v95
    v_add_f32 v7, v7, v92
    v_cvt_pk_bf16_f32 v126, v92, v93
    v_add_f32 v7, v7, v93
    v_cvt_pk_bf16_f32 v127, v94, v95
    v_add_f32 v94, v94, v95
    v_add_f32 v7, v7, v94
    s_barrier
    ds_write_b128 v12, v[112:115] offset:0
    ds_write_b128 v12, v[116:119] offset:1024
    ds_write_b128 v12, v[120:123] offset:2048
    ds_write_b128 v12, v[124:127] offset:3072
    s_waitcnt lgkmcnt(0)
    s_barrier
    v_mov_b32 v80, v4
    v_mov_b32 v81, v5
    v_mov_b32 v82, v6
    v_mov_b32 v83, v7
    s_nop 1
    v_permlane16_swap_b32 v4, v80
    v_permlane16_swap_b32 v5, v81
    v_permlane16_swap_b32 v6, v82
    v_permlane16_swap_b32 v7, v83
    v_add_f32 v4, v4, v80
    v_add_f32 v5, v5, v81
    v_add_f32 v6, v6, v82
    v_add_f32 v7, v7, v83
    v_mov_b32 v80, v4
    v_mov_b32 v81, v5
    v_mov_b32 v82, v6
    v_mov_b32 v83, v7
    s_nop 1
    v_permlane32_swap_b32 v4, v80
    v_permlane32_swap_b32 v5, v81
    v_permlane32_swap_b32 v6, v82
    v_permlane32_swap_b32 v7, v83
    v_add_f32 v4, v4, v80
    v_add_f32 v5, v5, v81
    v_add_f32 v6, v6, v82
    v_add_f32 v7, v7, v83
    v_subrev_u32 v83, 0, v13
    ds_write_b128 v83, v[4:7]
    v_add_f32 v81, v4, v5
    v_add_f32 v82, v6, v7
    v_add_f32 v81, v81, v82
    v_mov_b32 v82, 0x4e800000
    v_cmp_nlt_f32 vcc, v81, v82
    s_nop 1
    s_cmp_lg_u64 vcc, 0
    s_cselect_b32 s48, 1, 0
    s_lshl_b32 s49, s36, 6
    s_add_u32 s49, s49, 151552
    v_mov_b32 v80, s48
    v_mov_b32 v81, s49
    ds_write_b32 v81, v80
    s_waitcnt lgkmcnt(0)
    s_barrier
    v_mbcnt_lo_u32_b32 v2, -1, 0
    v_mbcnt_hi_u32_b32 v2, -1, v2
    v_and_b32 v80, 3, v2
    v_lshlrev_b32 v80, 6, v80
    v_add_u32 v80, 151552, v80
    ds_read_b32 v81, v80
    s_waitcnt lgkmcnt(0)
    v_cmp_ne_u32 vcc, 0, v81
    s_cmp_lg_u32 s39, 0
    s_cbranch_scc1 L_fb_qk_skip
    s_cbranch_vccnz L_fb_qk
L_fb_qk_skip:
    s_mov_b32 s28, s10
    s_mov_b32 s29, s11
    s_mov_b32 s30, 0x1000000
    s_mov_b32 s31, 0x20000
    s_barrier
    v_lshrrev_b32 v4, 5, v2
    v_and_b32 v6, 31, v2
    v_xor_b32 v6, v6, v4
    v_lshlrev_b32 v6, 4, v6
    v_lshl_add_u32 v6, v4, 9, v6
    s_lshl_b32 s48, s36, 13
    v_lshlrev_b32 v7, 4, v2
    v_add_u32 v7, s48, v7
    s_add_u32 s48, s48, s53
    ds_read_b128 v[16:19], v7 offset:0
    ds_read_b128 v[20:23], v7 offset:1024
    ds_read_b128 v[24:27], v7 offset:2048
    ds_read_b128 v[28:31], v7 offset:3072
    ds_read_b128 v[32:35], v7 offset:4096
    ds_read_b128 v[36:39], v7 offset:5120
    ds_read_b128 v[40:43], v7 offset:6144
    ds_read_b128 v[44:47], v7 offset:7168
    v_xor_b32 v8, 0, v6
    v_xor_b32 v9, 32, v6
    v_xor_b32 v10, 64, v6
    v_xor_b32 v11, 96, v6
    v_xor_b32 v12, 128, v6
    v_xor_b32 v13, 160, v6
    v_xor_b32 v14, 192, v6
    v_xor_b32 v15, 224, v6
    s_waitcnt lgkmcnt(7)
    buffer_store_dwordx4 v[16:19], v8, s[28:31], s48 offen offset:0 nt
    s_waitcnt lgkmcnt(6)
    buffer_store_dwordx4 v[20:23], v9, s[28:31], s48 offen offset:1024 nt
    s_waitcnt lgkmcnt(5)
    buffer_store_dwordx4 v[24:27], v10, s[28:31], s48 offen offset:2048 nt
    s_waitcnt lgkmcnt(4)
    buffer_store_dwordx4 v[28:31], v11, s[28:31], s48 offen offset:3072 nt
    s_add_u32 s48, s48, 4096
    s_waitcnt lgkmcnt(3)
    buffer_store_dwordx4 v[32:35], v12, s[28:31], s48 offen offset:0 nt
    s_waitcnt lgkmcnt(2)
    buffer_store_dwordx4 v[36:39], v13, s[28:31], s48 offen offset:1024 nt
    s_waitcnt lgkmcnt(1)
    buffer_store_dwordx4 v[40:43], v14, s[28:31], s48 offen offset:2048 nt
    s_waitcnt lgkmcnt(0)
    buffer_store_dwordx4 v[44:47], v15, s[28:31], s48 offen offset:3072 nt
    s_branch L_end
L_fb_qk:
    s_mov_b32 s39, 1
    v_mov_b32 v4, 0xff800000
    v_mov_b32 v5, 0xff800000
    v_mov_b32 v6, 0xff800000
    v_mov_b32 v7, 0xff800000
    s_mov_b32 s40, 32
L_fb_qk_loop:
    s_barrier
    s_barrier
    ds_read_b128 v[16:19], v8 offset:0
    ds_read_b128 v[20:23], v9 offset:0
    ds_read_b128 v[24:27], v10 offset:0
    ds_read_b128 v[28:31], v11 offset:0
    ds_read_b128 v[32:35], v8 offset:256
    ds_read_b128 v[36:39], v9 offset:256
    ds_read_b128 v[40:43], v10 offset:256
    ds_read_b128 v[44:47], v11 offset:256
    s_waitcnt lgkmcnt(0)
    ds_read_b128 v[48:51], v8 offset:8192
    ds_read_b128 v[52:55], v9 offset:8192
    ds_read_b128 v[56:59], v10 offset:8192
    ds_read_b128 v[60:63], v11 offset:8192
    ds_read_b128 v[64:67], v8 offset:8448
    ds_read_b128 v[68:71], v9 offset:8448
    ds_read_b128 v[72:75], v10 offset:8448
    ds_read_b128 v[76:79], v11 offset:8448
    s_waitcnt lgkmcnt(0)
    v_mfma_f32_16x16x32_bf16 v[80:83], v[16:19], a[0:3], 0
    v_mfma_f32_16x16x32_bf16 v[80:83], v[20:23], a[4:7], v[80:83]
    v_mfma_f32_16x16x32_bf16 v[80:83], v[24:27], a[8:11], v[80:83]
    v_mfma_f32_16x16x32_bf16 v[80:83], v[28:31], a[12:15], v[80:83]
    v_mfma_f32_16x16x32_bf16 v[80:83], v[32:35], a[16:19], v[80:83]
    v_mfma_f32_16x16x32_bf16 v[80:83], v[36:39], a[20:23], v[80:83]
    v_mfma_f32_16x16x32_bf16 v[80:83], v[40:43], a[24:27], v[80:83]
    v_mfma_f32_16x16x32_bf16 v[80:83], v[44:47], a[28:31], v[80:83]
    v_mfma_f32_16x16x32_bf16 v[84:87], v[16:19], a[32:35], 0
    v_mfma_f32_16x16x32_bf16 v[84:87], v[20:23], a[36:39], v[84:87]
    v_mfma_f32_16x16x32_bf16 v[84:87], v[24:27], a[40:43], v[84:87]
    v_mfma_f32_16x16x32_bf16 v[84:87], v[28:31], a[44:47], v[84:87]
    v_mfma_f32_16x16x32_bf16 v[84:87], v[32:35], a[48:51], v[84:87]
    v_mfma_f32_16x16x32_bf16 v[84:87], v[36:39], a[52:55], v[84:87]
    v_mfma_f32_16x16x32_bf16 v[84:87], v[40:43], a[56:59], v[84:87]
    v_mfma_f32_16x16x32_bf16 v[84:87], v[44:47], a[60:63], v[84:87]
    v_mfma_f32_16x16x32_bf16 v[88:91], v[16:19], v[128:131], 0
    v_mfma_f32_16x16x32_bf16 v[88:91], v[20:23], v[132:135], v[88:91]
    v_mfma_f32_16x16x32_bf16 v[88:91], v[24:27], v[136:139], v[88:91]
    v_mfma_f32_16x16x32_bf16 v[88:91], v[28:31], v[140:143], v[88:91]
    v_mfma_f32_16x16x32_bf16 v[88:91], v[32:35], v[144:147], v[88:91]
    v_mfma_f32_16x16x32_bf16 v[88:91], v[36:39], v[148:151], v[88:91]
    v_mfma_f32_16x16x32_bf16 v[88:91], v[40:43], v[152:155], v[88:91]
    v_mfma_f32_16x16x32_bf16 v[88:91], v[44:47], v[156:159], v[88:91]
    v_mfma_f32_16x16x32_bf16 v[92:95], v[16:19], v[160:163], 0
    v_mfma_f32_16x16x32_bf16 v[92:95], v[20:23], v[164:167], v[92:95]
    v_mfma_f32_16x16x32_bf16 v[92:95], v[24:27], v[168:171], v[92:95]
    v_mfma_f32_16x16x32_bf16 v[92:95], v[28:31], v[172:175], v[92:95]
    v_mfma_f32_16x16x32_bf16 v[92:95], v[32:35], v[176:179], v[92:95]
    v_mfma_f32_16x16x32_bf16 v[92:95], v[36:39], v[180:183], v[92:95]
    v_mfma_f32_16x16x32_bf16 v[92:95], v[40:43], v[184:187], v[92:95]
    v_mfma_f32_16x16x32_bf16 v[92:95], v[44:47], v[188:191], v[92:95]
    s_nop 7
    s_nop 1
    v_max3_f32 v4, v4, v80, v81
    v_max3_f32 v4, v4, v82, v83
    v_max3_f32 v5, v5, v84, v85
    v_max3_f32 v5, v5, v86, v87
    v_max3_f32 v6, v6, v88, v89
    v_max3_f32 v6, v6, v90, v91
    v_max3_f32 v7, v7, v92, v93
    v_max3_f32 v7, v7, v94, v95
    s_nop 3
    v_mfma_f32_16x16x32_bf16 v[80:83], v[48:51], a[0:3], 0
    v_mfma_f32_16x16x32_bf16 v[80:83], v[52:55], a[4:7], v[80:83]
    v_mfma_f32_16x16x32_bf16 v[80:83], v[56:59], a[8:11], v[80:83]
    v_mfma_f32_16x16x32_bf16 v[80:83], v[60:63], a[12:15], v[80:83]
    v_mfma_f32_16x16x32_bf16 v[80:83], v[64:67], a[16:19], v[80:83]
    v_mfma_f32_16x16x32_bf16 v[80:83], v[68:71], a[20:23], v[80:83]
    v_mfma_f32_16x16x32_bf16 v[80:83], v[72:75], a[24:27], v[80:83]
    v_mfma_f32_16x16x32_bf16 v[80:83], v[76:79], a[28:31], v[80:83]
    v_mfma_f32_16x16x32_bf16 v[84:87], v[48:51], a[32:35], 0
    v_mfma_f32_16x16x32_bf16 v[84:87], v[52:55], a[36:39], v[84:87]
    v_mfma_f32_16x16x32_bf16 v[84:87], v[56:59], a[40:43], v[84:87]
    v_mfma_f32_16x16x32_bf16 v[84:87], v[60:63], a[44:47], v[84:87]
    v_mfma_f32_16x16x32_bf16 v[84:87], v[64:67], a[48:51], v[84:87]
    v_mfma_f32_16x16x32_bf16 v[84:87], v[68:71], a[52:55], v[84:87]
    v_mfma_f32_16x16x32_bf16 v[84:87], v[72:75], a[56:59], v[84:87]
    v_mfma_f32_16x16x32_bf16 v[84:87], v[76:79], a[60:63], v[84:87]
    v_mfma_f32_16x16x32_bf16 v[88:91], v[48:51], v[128:131], 0
    v_mfma_f32_16x16x32_bf16 v[88:91], v[52:55], v[132:135], v[88:91]
    v_mfma_f32_16x16x32_bf16 v[88:91], v[56:59], v[136:139], v[88:91]
    v_mfma_f32_16x16x32_bf16 v[88:91], v[60:63], v[140:143], v[88:91]
    v_mfma_f32_16x16x32_bf16 v[88:91], v[64:67], v[144:147], v[88:91]
    v_mfma_f32_16x16x32_bf16 v[88:91], v[68:71], v[148:151], v[88:91]
    v_mfma_f32_16x16x32_bf16 v[88:91], v[72:75], v[152:155], v[88:91]
    v_mfma_f32_16x16x32_bf16 v[88:91], v[76:79], v[156:159], v[88:91]
    v_mfma_f32_16x16x32_bf16 v[92:95], v[48:51], v[160:163], 0
    v_mfma_f32_16x16x32_bf16 v[92:95], v[52:55], v[164:167], v[92:95]
    v_mfma_f32_16x16x32_bf16 v[92:95], v[56:59], v[168:171], v[92:95]
    v_mfma_f32_16x16x32_bf16 v[92:95], v[60:63], v[172:175], v[92:95]
    v_mfma_f32_16x16x32_bf16 v[92:95], v[64:67], v[176:179], v[92:95]
    v_mfma_f32_16x16x32_bf16 v[92:95], v[68:71], v[180:183], v[92:95]
    v_mfma_f32_16x16x32_bf16 v[92:95], v[72:75], v[184:187], v[92:95]
    v_mfma_f32_16x16x32_bf16 v[92:95], v[76:79], v[188:191], v[92:95]
    s_nop 7
    s_nop 1
    v_max3_f32 v4, v4, v80, v81
    v_max3_f32 v4, v4, v82, v83
    v_max3_f32 v5, v5, v84, v85
    v_max3_f32 v5, v5, v86, v87
    v_max3_f32 v6, v6, v88, v89
    v_max3_f32 v6, v6, v90, v91
    v_max3_f32 v7, v7, v92, v93
    v_max3_f32 v7, v7, v94, v95
    s_nop 3
    s_sub_u32 s40, s40, 1
    s_cmp_lg_u32 s40, 0
    s_cbranch_scc1 L_fb_qk_loop
    v_mov_b32 v80, v4
    v_mov_b32 v81, v5
    v_mov_b32 v82, v6
    v_mov_b32 v83, v7
    v_mov_b32 v84, v80
    v_mov_b32 v85, v81
    v_mov_b32 v86, v82
    v_mov_b32 v87, v83
    s_nop 1
    v_permlane16_swap_b32 v80, v84
    v_permlane16_swap_b32 v81, v85
    v_permlane16_swap_b32 v82, v86
    v_permlane16_swap_b32 v83, v87
    v_max_f32 v80, v80, v84
    v_max_f32 v81, v81, v85
    v_max_f32 v82, v82, v86
    v_max_f32 v83, v83, v87
    v_mov_b32 v84, v80
    v_mov_b32 v85, v81
    v_mov_b32 v86, v82
    v_mov_b32 v87, v83
    s_nop 1
    v_permlane32_swap_b32 v80, v84
    v_permlane32_swap_b32 v81, v85
    v_permlane32_swap_b32 v82, v86
    v_permlane32_swap_b32 v83, v87
    v_max_f32 v80, v80, v84
    v_max_f32 v81, v81, v85
    v_max_f32 v82, v82, v86
    v_max_f32 v83, v83, v87
    ds_write_b128 v13, v[80:83]
    s_waitcnt lgkmcnt(0)
    s_barrier
    v_xor_b32 v7, 1024, v13
    ds_read_b128 v[84:87], v7
    v_mov_b32 v4, 0
    v_mov_b32 v5, 0
    v_mov_b32 v6, 0
    v_mov_b32 v7, 0
    s_waitcnt lgkmcnt(0)
    v_max_f32 v80, v80, v84
    v_max_f32 v81, v81, v85
    v_max_f32 v82, v82, v86
    v_max_f32 v83, v83, v87
    v_sub_f32 v84, 0, v80
    v_sub_f32 v85, 0, v81
    v_sub_f32 v86, 0, v82
    v_sub_f32 v87, 0, v83
    v_mov_b32 v96, v84
    v_mov_b32 v97, v84
    v_mov_b32 v98, v84
    v_mov_b32 v99, v84
    v_mov_b32 v100, v85
    v_mov_b32 v101, v85
    v_mov_b32 v102, v85
    v_mov_b32 v103, v85
    v_mov_b32 v104, v86
    v_mov_b32 v105, v86
    v_mov_b32 v106, v86
    v_mov_b32 v107, v86
    v_mov_b32 v108, v87
    v_mov_b32 v109, v87
    v_mov_b32 v110, v87
    v_mov_b32 v111, v87
    s_barrier
    ds_read_b128 v[16:19], v8 offset:0
    ds_read_b128 v[20:23], v9 offset:0
    ds_read_b128 v[24:27], v10 offset:0
    ds_read_b128 v[28:31], v11 offset:0
    ds_read_b128 v[32:35], v8 offset:256
    ds_read_b128 v[36:39], v9 offset:256
    ds_read_b128 v[40:43], v10 offset:256
    ds_read_b128 v[44:47], v11 offset:256
    s_waitcnt lgkmcnt(0)
    ds_read_b128 v[48:51], v8 offset:8192
    ds_read_b128 v[52:55], v9 offset:8192
    ds_read_b128 v[56:59], v10 offset:8192
    ds_read_b128 v[60:63], v11 offset:8192
    ds_read_b128 v[64:67], v8 offset:8448
    ds_read_b128 v[68:71], v9 offset:8448
    ds_read_b128 v[72:75], v10 offset:8448
    ds_read_b128 v[76:79], v11 offset:8448
    s_waitcnt lgkmcnt(0)
    s_barrier
    v_mfma_f32_16x16x32_bf16 v[80:83], v[16:19], a[0:3], v[96:99]
    v_mfma_f32_16x16x32_bf16 v[80:83], v[20:23], a[4:7], v[80:83]
    v_mfma_f32_16x16x32_bf16 v[80:83], v[24:27], a[8:11], v[80:83]
    v_mfma_f32_16x16x32_bf16 v[80:83], v[28:31], a[12:15], v[80:83]
    v_mfma_f32_16x16x32_bf16 v[80:83], v[32:35], a[16:19], v[80:83]
    v_mfma_f32_16x16x32_bf16 v[80:83], v[36:39], a[20:23], v[80:83]
    v_mfma_f32_16x16x32_bf16 v[80:83], v[40:43], a[24:27], v[80:83]
    v_mfma_f32_16x16x32_bf16 v[80:83], v[44:47], a[28:31], v[80:83]
    v_mfma_f32_16x16x32_bf16 v[84:87], v[16:19], a[32:35], v[100:103]
    v_mfma_f32_16x16x32_bf16 v[84:87], v[20:23], a[36:39], v[84:87]
    v_mfma_f32_16x16x32_bf16 v[84:87], v[24:27], a[40:43], v[84:87]
    v_mfma_f32_16x16x32_bf16 v[84:87], v[28:31], a[44:47], v[84:87]
    v_mfma_f32_16x16x32_bf16 v[84:87], v[32:35], a[48:51], v[84:87]
    v_mfma_f32_16x16x32_bf16 v[84:87], v[36:39], a[52:55], v[84:87]
    v_mfma_f32_16x16x32_bf16 v[84:87], v[40:43], a[56:59], v[84:87]
    v_mfma_f32_16x16x32_bf16 v[84:87], v[44:47], a[60:63], v[84:87]
    v_mfma_f32_16x16x32_bf16 v[88:91], v[16:19], v[128:131], v[104:107]
    v_mfma_f32_16x16x32_bf16 v[88:91], v[20:23], v[132:135], v[88:91]
    v_mfma_f32_16x16x32_bf16 v[88:91], v[24:27], v[136:139], v[88:91]
    v_mfma_f32_16x16x32_bf16 v[88:91], v[28:31], v[140:143], v[88:91]
    v_mfma_f32_16x16x32_bf16 v[88:91], v[32:35], v[144:147], v[88:91]
    v_mfma_f32_16x16x32_bf16 v[88:91], v[36:39], v[148:151], v[88:91]
    v_mfma_f32_16x16x32_bf16 v[88:91], v[40:43], v[152:155], v[88:91]
    v_mfma_f32_16x16x32_bf16 v[88:91], v[44:47], v[156:159], v[88:91]
    v_mfma_f32_16x16x32_bf16 v[92:95], v[16:19], v[160:163], v[108:111]
    v_mfma_f32_16x16x32_bf16 v[92:95], v[20:23], v[164:167], v[92:95]
    v_mfma_f32_16x16x32_bf16 v[92:95], v[24:27], v[168:171], v[92:95]
    v_mfma_f32_16x16x32_bf16 v[92:95], v[28:31], v[172:175], v[92:95]
    v_mfma_f32_16x16x32_bf16 v[92:95], v[32:35], v[176:179], v[92:95]
    v_mfma_f32_16x16x32_bf16 v[92:95], v[36:39], v[180:183], v[92:95]
    v_mfma_f32_16x16x32_bf16 v[92:95], v[40:43], v[184:187], v[92:95]
    v_mfma_f32_16x16x32_bf16 v[92:95], v[44:47], v[188:191], v[92:95]
    s_nop 7
    s_nop 1
    v_exp_f32 v80, v80
    v_exp_f32 v81, v81
    v_exp_f32 v82, v82
    v_exp_f32 v83, v83
    v_add_f32 v4, v4, v80
    v_cvt_pk_bf16_f32 v112, v80, v81
    v_add_f32 v4, v4, v81
    v_cvt_pk_bf16_f32 v113, v82, v83
    v_add_f32 v82, v82, v83
    v_add_f32 v4, v4, v82
    v_exp_f32 v84, v84
    v_exp_f32 v85, v85
    v_exp_f32 v86, v86
    v_exp_f32 v87, v87
    v_add_f32 v5, v5, v84
    v_cvt_pk_bf16_f32 v116, v84, v85
    v_add_f32 v5, v5, v85
    v_cvt_pk_bf16_f32 v117, v86, v87
    v_add_f32 v86, v86, v87
    v_add_f32 v5, v5, v86
    v_exp_f32 v88, v88
    v_exp_f32 v89, v89
    v_exp_f32 v90, v90
    v_exp_f32 v91, v91
    v_add_f32 v6, v6, v88
    v_cvt_pk_bf16_f32 v120, v88, v89
    v_add_f32 v6, v6, v89
    v_cvt_pk_bf16_f32 v121, v90, v91
    v_add_f32 v90, v90, v91
    v_add_f32 v6, v6, v90
    v_exp_f32 v92, v92
    v_exp_f32 v93, v93
    v_exp_f32 v94, v94
    v_exp_f32 v95, v95
    v_add_f32 v7, v7, v92
    v_cvt_pk_bf16_f32 v124, v92, v93
    v_add_f32 v7, v7, v93
    v_cvt_pk_bf16_f32 v125, v94, v95
    v_add_f32 v94, v94, v95
    v_add_f32 v7, v7, v94
    s_nop 3
    v_mfma_f32_16x16x32_bf16 v[80:83], v[48:51], a[0:3], v[96:99]
    v_mfma_f32_16x16x32_bf16 v[80:83], v[52:55], a[4:7], v[80:83]
    v_mfma_f32_16x16x32_bf16 v[80:83], v[56:59], a[8:11], v[80:83]
    v_mfma_f32_16x16x32_bf16 v[80:83], v[60:63], a[12:15], v[80:83]
    v_mfma_f32_16x16x32_bf16 v[80:83], v[64:67], a[16:19], v[80:83]
    v_mfma_f32_16x16x32_bf16 v[80:83], v[68:71], a[20:23], v[80:83]
    v_mfma_f32_16x16x32_bf16 v[80:83], v[72:75], a[24:27], v[80:83]
    v_mfma_f32_16x16x32_bf16 v[80:83], v[76:79], a[28:31], v[80:83]
    v_mfma_f32_16x16x32_bf16 v[84:87], v[48:51], a[32:35], v[100:103]
    v_mfma_f32_16x16x32_bf16 v[84:87], v[52:55], a[36:39], v[84:87]
    v_mfma_f32_16x16x32_bf16 v[84:87], v[56:59], a[40:43], v[84:87]
    v_mfma_f32_16x16x32_bf16 v[84:87], v[60:63], a[44:47], v[84:87]
    v_mfma_f32_16x16x32_bf16 v[84:87], v[64:67], a[48:51], v[84:87]
    v_mfma_f32_16x16x32_bf16 v[84:87], v[68:71], a[52:55], v[84:87]
    v_mfma_f32_16x16x32_bf16 v[84:87], v[72:75], a[56:59], v[84:87]
    v_mfma_f32_16x16x32_bf16 v[84:87], v[76:79], a[60:63], v[84:87]
    v_mfma_f32_16x16x32_bf16 v[88:91], v[48:51], v[128:131], v[104:107]
    v_mfma_f32_16x16x32_bf16 v[88:91], v[52:55], v[132:135], v[88:91]
    v_mfma_f32_16x16x32_bf16 v[88:91], v[56:59], v[136:139], v[88:91]
    v_mfma_f32_16x16x32_bf16 v[88:91], v[60:63], v[140:143], v[88:91]
    v_mfma_f32_16x16x32_bf16 v[88:91], v[64:67], v[144:147], v[88:91]
    v_mfma_f32_16x16x32_bf16 v[88:91], v[68:71], v[148:151], v[88:91]
    v_mfma_f32_16x16x32_bf16 v[88:91], v[72:75], v[152:155], v[88:91]
    v_mfma_f32_16x16x32_bf16 v[88:91], v[76:79], v[156:159], v[88:91]
    v_mfma_f32_16x16x32_bf16 v[92:95], v[48:51], v[160:163], v[108:111]
    v_mfma_f32_16x16x32_bf16 v[92:95], v[52:55], v[164:167], v[92:95]
    v_mfma_f32_16x16x32_bf16 v[92:95], v[56:59], v[168:171], v[92:95]
    v_mfma_f32_16x16x32_bf16 v[92:95], v[60:63], v[172:175], v[92:95]
    v_mfma_f32_16x16x32_bf16 v[92:95], v[64:67], v[176:179], v[92:95]
    v_mfma_f32_16x16x32_bf16 v[92:95], v[68:71], v[180:183], v[92:95]
    v_mfma_f32_16x16x32_bf16 v[92:95], v[72:75], v[184:187], v[92:95]
    v_mfma_f32_16x16x32_bf16 v[92:95], v[76:79], v[188:191], v[92:95]
    s_nop 7
    s_nop 1
    v_exp_f32 v80, v80
    v_exp_f32 v81, v81
    v_exp_f32 v82, v82
    v_exp_f32 v83, v83
    v_add_f32 v4, v4, v80
    v_cvt_pk_bf16_f32 v114, v80, v81
    v_add_f32 v4, v4, v81
    v_cvt_pk_bf16_f32 v115, v82, v83
    v_add_f32 v82, v82, v83
    v_add_f32 v4, v4, v82
    v_exp_f32 v84, v84
    v_exp_f32 v85, v85
    v_exp_f32 v86, v86
    v_exp_f32 v87, v87
    v_add_f32 v5, v5, v84
    v_cvt_pk_bf16_f32 v118, v84, v85
    v_add_f32 v5, v5, v85
    v_cvt_pk_bf16_f32 v119, v86, v87
    v_add_f32 v86, v86, v87
    v_add_f32 v5, v5, v86
    v_exp_f32 v88, v88
    v_exp_f32 v89, v89
    v_exp_f32 v90, v90
    v_exp_f32 v91, v91
    v_add_f32 v6, v6, v88
    v_cvt_pk_bf16_f32 v122, v88, v89
    v_add_f32 v6, v6, v89
    v_cvt_pk_bf16_f32 v123, v90, v91
    v_add_f32 v90, v90, v91
    v_add_f32 v6, v6, v90
    v_exp_f32 v92, v92
    v_exp_f32 v93, v93
    v_exp_f32 v94, v94
    v_exp_f32 v95, v95
    v_add_f32 v7, v7, v92
    v_cvt_pk_bf16_f32 v126, v92, v93
    v_add_f32 v7, v7, v93
    v_cvt_pk_bf16_f32 v127, v94, v95
    v_add_f32 v94, v94, v95
    v_add_f32 v7, v7, v94
    s_nop 3
    s_branch L_qk_main
L_pv:
    s_sub_u32 s54, s36, 4
    s_lshl_b32 s48, s54, 2
    s_lshl_b32 s49, s54, 11
    v_add_u32 v7, s48, v4
    v_add_u32 v7, 0, v7
    v_xor_b32 v21, v6, v7
    v_lshlrev_b32 v21, 4, v21
    v_lshl_add_u32 v21, v4, 9, v21
    v_add_u32 v17, s49, v21
    v_add_u32 v7, s48, v4
    v_add_u32 v7, 2, v7
    v_xor_b32 v21, v6, v7
    v_lshlrev_b32 v21, 4, v21
    v_lshl_add_u32 v21, v4, 9, v21
    v_add_u32 v18, s49, v21
    s_lshl_b32 s41, s37, 20
    s_mov_b32 s42, s41
    s_add_u32 s43, s49, 0
    s_add_u32 s44, s49, 65536
    s_waitcnt lgkmcnt(0)
    s_mov_b32 s20, s6
    s_mov_b32 s21, s7
    s_mov_b32 s22, 0x1000000
    s_mov_b32 s23, 0x20000
    s_mov_b32 s24, s8
    s_mov_b32 s25, s9
    s_mov_b32 s26, 0x1000000
    s_mov_b32 s27, 0x20000
    s_mov_b32 s28, s10
    s_mov_b32 s29, s11
    s_mov_b32 s30, 0x1000000
    s_mov_b32 s31, 0x20000
    s_setprio 3
    s_add_u32 m0, s43, 0
    s_nop 0
    buffer_load_dwordx4 v17, s[20:23], s41 offen nt lds
    buffer_load_dwordx4 v18, s[20:23], s41 offen offset:1024 nt lds
    s_add_u32 s41, s41, 8192
    s_add_u32 m0, s43, 8192
    s_nop 0
    buffer_load_dwordx4 v17, s[20:23], s41 offen nt lds
    buffer_load_dwordx4 v18, s[20:23], s41 offen offset:1024 nt lds
    s_add_u32 s41, s41, 8192
    s_add_u32 m0, s43, 16384
    s_nop 0
    buffer_load_dwordx4 v17, s[20:23], s41 offen nt lds
    buffer_load_dwordx4 v18, s[20:23], s41 offen offset:1024 nt lds
    s_add_u32 s41, s41, 8192
    s_add_u32 m0, s43, 24576
    s_nop 0
    buffer_load_dwordx4 v17, s[20:23], s41 offen nt lds
    buffer_load_dwordx4 v18, s[20:23], s41 offen offset:1024 nt lds
    s_add_u32 s41, s41, 8192
    s_setprio 0
    v_add_u32 v7, s48, v4
    v_add_u32 v7, 0, v7
    v_and_b32 v7, 7, v7
    v_lshlrev_b32 v7, 1, v7
    v_xor_b32 v21, v6, v7
    v_lshlrev_b32 v21, 4, v21
    v_lshl_add_u32 v21, v4, 9, v21
    v_add_u32 v19, s49, v21
    v_add_u32 v7, s48, v4
    v_add_u32 v7, 2, v7
    v_and_b32 v7, 7, v7
    v_lshlrev_b32 v7, 1, v7
    v_xor_b32 v21, v6, v7
    v_lshlrev_b32 v21, 4, v21
    v_lshl_add_u32 v21, v4, 9, v21
    v_add_u32 v20, s49, v21
    s_and_b32 s49, s36, 1
    s_lshl_b32 s49, s49, 15
    s_add_u32 s52, s53, s49
    v_lshrrev_b32 v4, 2, v3
    v_lshl_add_u32 v6, v1, 2, v4
    v_and_b32 v7, 7, v6
    v_lshlrev_b32 v6, 9, v6
    s_lshr_b32 s48, s54, 1
    s_lshl_b32 s48, s48, 8
    s_add_u32 s48, s48, 65536
    v_add_u32 v6, s48, v6
    v_bfe_u32 v21, v3, 1, 1
    v_lshl_add_u32 v6, v21, 4, v6
    v_and_b32 v21, 1, v3
    v_lshl_add_u32 v6, v21, 3, v6
    v_xor_b32 v21, 0, v7
    v_lshl_add_u32 v8, v21, 5, v6
    v_xor_b32 v21, 1, v7
    v_lshl_add_u32 v9, v21, 5, v6
    v_xor_b32 v21, 2, v7
    v_lshl_add_u32 v10, v21, 5, v6
    v_xor_b32 v21, 3, v7
    v_lshl_add_u32 v11, v21, 5, v6
    v_xor_b32 v21, 4, v7
    v_lshl_add_u32 v12, v21, 5, v6
    v_xor_b32 v21, 5, v7
    v_lshl_add_u32 v13, v21, 5, v6
    v_xor_b32 v21, 6, v7
    v_lshl_add_u32 v14, v21, 5, v6
    v_xor_b32 v21, 7, v7
    v_lshl_add_u32 v15, v21, 5, v6
    s_and_b32 s48, s36, 1
    s_lshl_b32 s48, s48, 13
    s_add_u32 s48, s48, 131072
    v_lshlrev_b32 v21, 4, v2
    v_add_u32 v16, s48, v21
    v_mov_b32 v64, 0
    v_mov_b32 v65, 0
    v_mov_b32 v66, 0
    v_mov_b32 v67, 0
    v_mov_b32 v68, 0
    v_mov_b32 v69, 0
    v_mov_b32 v70, 0
    v_mov_b32 v71, 0
    v_mov_b32 v72, 0
    v_mov_b32 v73, 0
    v_mov_b32 v74, 0
    v_mov_b32 v75, 0
    v_mov_b32 v76, 0
    v_mov_b32 v77, 0
    v_mov_b32 v78, 0
    v_mov_b32 v79, 0
    v_mov_b32 v80, 0
    v_mov_b32 v81, 0
    v_mov_b32 v82, 0
    v_mov_b32 v83, 0
    v_mov_b32 v84, 0
    v_mov_b32 v85, 0
    v_mov_b32 v86, 0
    v_mov_b32 v87, 0
    v_mov_b32 v88, 0
    v_mov_b32 v89, 0
    v_mov_b32 v90, 0
    v_mov_b32 v91, 0
    v_mov_b32 v92, 0
    v_mov_b32 v93, 0
    v_mov_b32 v94, 0
    v_mov_b32 v95, 0
    v_mov_b32 v96, 0
    v_mov_b32 v97, 0
    v_mov_b32 v98, 0
    v_mov_b32 v99, 0
    v_mov_b32 v100, 0
    v_mov_b32 v101, 0
    v_mov_b32 v102, 0
    v_mov_b32 v103, 0
    v_mov_b32 v104, 0
    v_mov_b32 v105, 0
    v_mov_b32 v106, 0
    v_mov_b32 v107, 0
    v_mov_b32 v108, 0
    v_mov_b32 v109, 0
    v_mov_b32 v110, 0
    v_mov_b32 v111, 0
    v_mov_b32 v112, 0
    v_mov_b32 v113, 0
    v_mov_b32 v114, 0
    v_mov_b32 v115, 0
    v_mov_b32 v116, 0
    v_mov_b32 v117, 0
    v_mov_b32 v118, 0
    v_mov_b32 v119, 0
    v_mov_b32 v120, 0
    v_mov_b32 v121, 0
    v_mov_b32 v122, 0
    v_mov_b32 v123, 0
    v_mov_b32 v124, 0
    v_mov_b32 v125, 0
    v_mov_b32 v126, 0
    v_mov_b32 v127, 0
    v_mov_b32 v128, 0
    v_mov_b32 v129, 0
    v_mov_b32 v130, 0
    v_mov_b32 v131, 0
    v_mov_b32 v132, 0
    v_mov_b32 v133, 0
    v_mov_b32 v134, 0
    v_mov_b32 v135, 0
    v_mov_b32 v136, 0
    v_mov_b32 v137, 0
    v_mov_b32 v138, 0
    v_mov_b32 v139, 0
    v_mov_b32 v140, 0
    v_mov_b32 v141, 0
    v_mov_b32 v142, 0
    v_mov_b32 v143, 0
    v_mov_b32 v144, 0
    v_mov_b32 v145, 0
    v_mov_b32 v146, 0
    v_mov_b32 v147, 0
    v_mov_b32 v148, 0
    v_mov_b32 v149, 0
    v_mov_b32 v150, 0
    v_mov_b32 v151, 0
    v_mov_b32 v152, 0
    v_mov_b32 v153, 0
    v_mov_b32 v154, 0
    v_mov_b32 v155, 0
    v_mov_b32 v156, 0
    v_mov_b32 v157, 0
    v_mov_b32 v158, 0
    v_mov_b32 v159, 0
    v_mov_b32 v160, 0
    v_mov_b32 v161, 0
    v_mov_b32 v162, 0
    v_mov_b32 v163, 0
    v_mov_b32 v164, 0
    v_mov_b32 v165, 0
    v_mov_b32 v166, 0
    v_mov_b32 v167, 0
    v_mov_b32 v168, 0
    v_mov_b32 v169, 0
    v_mov_b32 v170, 0
    v_mov_b32 v171, 0
    v_mov_b32 v172, 0
    v_mov_b32 v173, 0
    v_mov_b32 v174, 0
    v_mov_b32 v175, 0
    v_mov_b32 v176, 0
    v_mov_b32 v177, 0
    v_mov_b32 v178, 0
    v_mov_b32 v179, 0
    v_mov_b32 v180, 0
    v_mov_b32 v181, 0
    v_mov_b32 v182, 0
    v_mov_b32 v183, 0
    v_mov_b32 v184, 0
    v_mov_b32 v185, 0
    v_mov_b32 v186, 0
    v_mov_b32 v187, 0
    v_mov_b32 v188, 0
    v_mov_b32 v189, 0
    v_mov_b32 v190, 0
    v_mov_b32 v191, 0
    v_accvgpr_write_b32 a0, 0
    v_accvgpr_write_b32 a1, 0
    v_accvgpr_write_b32 a2, 0
    v_accvgpr_write_b32 a3, 0
    v_accvgpr_write_b32 a4, 0
    v_accvgpr_write_b32 a5, 0
    v_accvgpr_write_b32 a6, 0
    v_accvgpr_write_b32 a7, 0
    v_accvgpr_write_b32 a8, 0
    v_accvgpr_write_b32 a9, 0
    v_accvgpr_write_b32 a10, 0
    v_accvgpr_write_b32 a11, 0
    v_accvgpr_write_b32 a12, 0
    v_accvgpr_write_b32 a13, 0
    v_accvgpr_write_b32 a14, 0
    v_accvgpr_write_b32 a15, 0
    v_accvgpr_write_b32 a16, 0
    v_accvgpr_write_b32 a17, 0
    v_accvgpr_write_b32 a18, 0
    v_accvgpr_write_b32 a19, 0
    v_accvgpr_write_b32 a20, 0
    v_accvgpr_write_b32 a21, 0
    v_accvgpr_write_b32 a22, 0
    v_accvgpr_write_b32 a23, 0
    v_accvgpr_write_b32 a24, 0
    v_accvgpr_write_b32 a25, 0
    v_accvgpr_write_b32 a26, 0
    v_accvgpr_write_b32 a27, 0
    v_accvgpr_write_b32 a28, 0
    v_accvgpr_write_b32 a29, 0
    v_accvgpr_write_b32 a30, 0
    v_accvgpr_write_b32 a31, 0
    v_accvgpr_write_b32 a32, 0
    v_accvgpr_write_b32 a33, 0
    v_accvgpr_write_b32 a34, 0
    v_accvgpr_write_b32 a35, 0
    v_accvgpr_write_b32 a36, 0
    v_accvgpr_write_b32 a37, 0
    v_accvgpr_write_b32 a38, 0
    v_accvgpr_write_b32 a39, 0
    v_accvgpr_write_b32 a40, 0
    v_accvgpr_write_b32 a41, 0
    v_accvgpr_write_b32 a42, 0
    v_accvgpr_write_b32 a43, 0
    v_accvgpr_write_b32 a44, 0
    v_accvgpr_write_b32 a45, 0
    v_accvgpr_write_b32 a46, 0
    v_accvgpr_write_b32 a47, 0
    v_accvgpr_write_b32 a48, 0
    v_accvgpr_write_b32 a49, 0
    v_accvgpr_write_b32 a50, 0
    v_accvgpr_write_b32 a51, 0
    v_accvgpr_write_b32 a52, 0
    v_accvgpr_write_b32 a53, 0
    v_accvgpr_write_b32 a54, 0
    v_accvgpr_write_b32 a55, 0
    v_accvgpr_write_b32 a56, 0
    v_accvgpr_write_b32 a57, 0
    v_accvgpr_write_b32 a58, 0
    v_accvgpr_write_b32 a59, 0
    v_accvgpr_write_b32 a60, 0
    v_accvgpr_write_b32 a61, 0
    v_accvgpr_write_b32 a62, 0
    v_accvgpr_write_b32 a63, 0
    s_waitcnt vmcnt(0)
    s_barrier
    s_add_u32 m0, s43, 32768
    s_nop 0
    buffer_load_dwordx4 v17, s[20:23], s41 offen nt lds
    buffer_load_dwordx4 v18, s[20:23], s41 offen offset:1024 nt lds
    s_add_u32 s41, s41, 8192
    s_add_u32 m0, s43, 40960
    s_nop 0
    buffer_load_dwordx4 v17, s[20:23], s41 offen nt lds
    buffer_load_dwordx4 v18, s[20:23], s41 offen offset:1024 nt lds
    s_add_u32 s41, s41, 8192
    s_add_u32 m0, s43, 49152
    s_nop 0
    buffer_load_dwordx4 v17, s[20:23], s41 offen nt lds
    buffer_load_dwordx4 v18, s[20:23], s41 offen offset:1024 nt lds
    s_add_u32 s41, s41, 8192
    s_add_u32 m0, s43, 57344
    s_nop 0
    buffer_load_dwordx4 v17, s[20:23], s41 offen nt lds
    buffer_load_dwordx4 v18, s[20:23], s41 offen offset:1024 nt lds
    s_add_u32 s41, s41, 8192
    s_barrier
    s_barrier
    s_barrier
    s_add_u32 m0, s44, 0
    s_nop 0
    buffer_load_dwordx4 v19, s[24:27], s42 offen nt lds
    buffer_load_dwordx4 v20, s[24:27], s42 offen offset:1024 nt lds
    s_add_u32 s42, s42, 8192
    s_add_u32 m0, s44, 8192
    s_nop 0
    buffer_load_dwordx4 v19, s[24:27], s42 offen nt lds
    buffer_load_dwordx4 v20, s[24:27], s42 offen offset:1024 nt lds
    s_add_u32 s42, s42, 8192
    s_add_u32 m0, s44, 16384
    s_nop 0
    buffer_load_dwordx4 v19, s[24:27], s42 offen nt lds
    buffer_load_dwordx4 v20, s[24:27], s42 offen offset:1024 nt lds
    s_add_u32 s42, s42, 8192
    s_add_u32 m0, s44, 24576
    s_nop 0
    buffer_load_dwordx4 v19, s[24:27], s42 offen nt lds
    buffer_load_dwordx4 v20, s[24:27], s42 offen offset:1024 nt lds
    s_add_u32 s42, s42, 8192
    s_barrier
    s_add_u32 m0, s43, 0
    s_nop 0
    buffer_load_dwordx4 v17, s[20:23], s41 offen nt lds
    buffer_load_dwordx4 v18, s[20:23], s41 offen offset:1024 nt lds
    s_add_u32 s41, s41, 8192
    s_add_u32 m0, s43, 8192
    s_nop 0
    buffer_load_dwordx4 v17, s[20:23], s41 offen nt lds
    buffer_load_dwordx4 v18, s[20:23], s41 offen offset:1024 nt lds
    s_add_u32 s41, s41, 8192
    s_add_u32 m0, s43, 16384
    s_nop 0
    buffer_load_dwordx4 v17, s[20:23], s41 offen nt lds
    buffer_load_dwordx4 v18, s[20:23], s41 offen offset:1024 nt lds
    s_add_u32 s41, s41, 8192
    s_add_u32 m0, s43, 24576
    s_nop 0
    buffer_load_dwordx4 v17, s[20:23], s41 offen nt lds
    buffer_load_dwordx4 v18, s[20:23], s41 offen offset:1024 nt lds
    s_add_u32 s41, s41, 8192
    s_waitcnt vmcnt(16)
L_pv_main:
    s_barrier
    s_mov_b32 s40, 14
.p2align 6
L_pv_loop:
    s_setprio 3
    v_mfma_f32_16x16x32_bf16 v[144:147], a[40:43], a[0:3], v[144:147]
    v_mfma_f32_16x16x32_bf16 v[144:147], a[44:47], a[16:19], v[144:147]
    v_mfma_f32_16x16x32_bf16 v[148:151], a[40:43], a[4:7], v[148:151]
    v_mfma_f32_16x16x32_bf16 v[148:151], a[44:47], a[20:23], v[148:151]
    v_mfma_f32_16x16x32_bf16 v[152:155], a[40:43], a[8:11], v[152:155]
    v_mfma_f32_16x16x32_bf16 v[152:155], a[44:47], a[24:27], v[152:155]
    v_mfma_f32_16x16x32_bf16 v[156:159], a[40:43], a[12:15], v[156:159]
    v_mfma_f32_16x16x32_bf16 v[156:159], a[44:47], a[28:31], v[156:159]
    v_mfma_f32_16x16x32_bf16 v[160:163], a[48:51], a[0:3], v[160:163]
    v_mfma_f32_16x16x32_bf16 v[160:163], a[52:55], a[16:19], v[160:163]
    v_mfma_f32_16x16x32_bf16 v[164:167], a[48:51], a[4:7], v[164:167]
    v_mfma_f32_16x16x32_bf16 v[164:167], a[52:55], a[20:23], v[164:167]
    v_mfma_f32_16x16x32_bf16 v[168:171], a[48:51], a[8:11], v[168:171]
    v_mfma_f32_16x16x32_bf16 v[168:171], a[52:55], a[24:27], v[168:171]
    v_mfma_f32_16x16x32_bf16 v[172:175], a[48:51], a[12:15], v[172:175]
    v_mfma_f32_16x16x32_bf16 v[172:175], a[52:55], a[28:31], v[172:175]
    s_add_u32 m0, s44, 32768
    v_mfma_f32_16x16x32_bf16 v[176:179], a[56:59], a[0:3], v[176:179]
    buffer_load_dwordx4 v19, s[24:27], s42 offen nt lds
    v_mfma_f32_16x16x32_bf16 v[176:179], a[60:63], a[16:19], v[176:179]
    v_mfma_f32_16x16x32_bf16 v[180:183], a[56:59], a[4:7], v[180:183]
    v_mfma_f32_16x16x32_bf16 v[180:183], a[60:63], a[20:23], v[180:183]
    v_mfma_f32_16x16x32_bf16 v[184:187], a[56:59], a[8:11], v[184:187]
    buffer_load_dwordx4 v20, s[24:27], s42 offen offset:1024 nt lds
    s_add_u32 s42, s42, 8192
    v_mfma_f32_16x16x32_bf16 v[184:187], a[60:63], a[24:27], v[184:187]
    v_mfma_f32_16x16x32_bf16 v[188:191], a[56:59], a[12:15], v[188:191]
    v_mfma_f32_16x16x32_bf16 v[188:191], a[60:63], a[28:31], v[188:191]
    s_setprio 1
    s_add_u32 m0, s44, 40960
    s_nop 0
    buffer_load_dwordx4 v19, s[24:27], s42 offen nt lds
    buffer_load_dwordx4 v20, s[24:27], s42 offen offset:1024 nt lds
    s_add_u32 s42, s42, 8192
    s_add_u32 m0, s44, 49152
    s_nop 0
    buffer_load_dwordx4 v19, s[24:27], s42 offen nt lds
    buffer_load_dwordx4 v20, s[24:27], s42 offen offset:1024 nt lds
    s_add_u32 s42, s42, 8192
    s_add_u32 m0, s44, 57344
    s_nop 0
    buffer_load_dwordx4 v19, s[24:27], s42 offen nt lds
    buffer_load_dwordx4 v20, s[24:27], s42 offen offset:1024 nt lds
    s_add_u32 s42, s42, 8192
    s_waitcnt vmcnt(16)
    s_barrier
    ds_read_b64_tr_b16 a[32:33], v8 offset:0
    ds_read_b64_tr_b16 a[34:35], v8 offset:8192
    ds_read_b64_tr_b16 a[36:37], v8 offset:16384
    ds_read_b64_tr_b16 a[38:39], v8 offset:24576
    ds_read_b128 a[0:3], v16 offset:0
    ds_read_b128 a[16:19], v16 offset:4096
    ds_read_b128 a[4:7], v16 offset:1024
    ds_read_b128 a[20:23], v16 offset:5120
    ds_read_b128 a[8:11], v16 offset:2048
    ds_read_b128 a[24:27], v16 offset:6144
    ds_read_b128 a[12:15], v16 offset:3072
    ds_read_b128 a[28:31], v16 offset:7168
    s_add_u32 m0, s43, 32768
    s_nop 0
    buffer_load_dwordx4 v17, s[20:23], s41 offen nt lds
    buffer_load_dwordx4 v18, s[20:23], s41 offen offset:1024 nt lds
    s_add_u32 s41, s41, 8192
    s_add_u32 m0, s43, 40960
    s_nop 0
    buffer_load_dwordx4 v17, s[20:23], s41 offen nt lds
    buffer_load_dwordx4 v18, s[20:23], s41 offen offset:1024 nt lds
    s_add_u32 s41, s41, 8192
    s_setprio 1
    s_waitcnt lgkmcnt(7)
    v_mfma_f32_16x16x32_bf16 v[64:67], a[32:35], a[0:3], v[64:67]
    ds_read_b64_tr_b16 a[40:41], v9 offset:0
    ds_read_b64_tr_b16 a[42:43], v9 offset:8192
    s_waitcnt lgkmcnt(8)
    v_mfma_f32_16x16x32_bf16 v[64:67], a[36:39], a[16:19], v[64:67]
    ds_read_b64_tr_b16 a[44:45], v9 offset:16384
    ds_read_b64_tr_b16 a[46:47], v9 offset:24576
    s_waitcnt lgkmcnt(9)
    v_mfma_f32_16x16x32_bf16 v[68:71], a[32:35], a[4:7], v[68:71]
    ds_read_b64_tr_b16 a[48:49], v10 offset:0
    ds_read_b64_tr_b16 a[50:51], v10 offset:8192
    s_waitcnt lgkmcnt(10)
    v_mfma_f32_16x16x32_bf16 v[68:71], a[36:39], a[20:23], v[68:71]
    ds_read_b64_tr_b16 a[52:53], v10 offset:16384
    ds_read_b64_tr_b16 a[54:55], v10 offset:24576
    s_waitcnt lgkmcnt(11)
    v_mfma_f32_16x16x32_bf16 v[72:75], a[32:35], a[8:11], v[72:75]
    ds_read_b64_tr_b16 a[56:57], v11 offset:0
    ds_read_b64_tr_b16 a[58:59], v11 offset:8192
    s_waitcnt lgkmcnt(12)
    v_mfma_f32_16x16x32_bf16 v[72:75], a[36:39], a[24:27], v[72:75]
    ds_read_b64_tr_b16 a[60:61], v11 offset:16384
    s_add_u32 m0, s43, 49152
    s_waitcnt lgkmcnt(12)
    v_mfma_f32_16x16x32_bf16 v[76:79], a[32:35], a[12:15], v[76:79]
    ds_read_b64_tr_b16 a[62:63], v11 offset:24576
    buffer_load_dwordx4 v17, s[20:23], s41 offen nt lds
    s_waitcnt lgkmcnt(12)
    v_mfma_f32_16x16x32_bf16 v[76:79], a[36:39], a[28:31], v[76:79]
    s_waitcnt lgkmcnt(10)
    v_mfma_f32_16x16x32_bf16 v[80:83], a[40:43], a[0:3], v[80:83]
    ds_read_b64_tr_b16 a[32:33], v12 offset:0
    ds_read_b64_tr_b16 a[34:35], v12 offset:8192
    s_waitcnt lgkmcnt(10)
    v_mfma_f32_16x16x32_bf16 v[80:83], a[44:47], a[16:19], v[80:83]
    ds_read_b64_tr_b16 a[36:37], v12 offset:16384
    ds_read_b64_tr_b16 a[38:39], v12 offset:24576
    v_mfma_f32_16x16x32_bf16 v[84:87], a[40:43], a[4:7], v[84:87]
    buffer_load_dwordx4 v18, s[20:23], s41 offen offset:1024 nt lds
    v_mfma_f32_16x16x32_bf16 v[84:87], a[44:47], a[20:23], v[84:87]
    v_mfma_f32_16x16x32_bf16 v[88:91], a[40:43], a[8:11], v[88:91]
    v_mfma_f32_16x16x32_bf16 v[88:91], a[44:47], a[24:27], v[88:91]
    s_add_u32 s41, s41, 8192
    v_mfma_f32_16x16x32_bf16 v[92:95], a[40:43], a[12:15], v[92:95]
    v_mfma_f32_16x16x32_bf16 v[92:95], a[44:47], a[28:31], v[92:95]
    s_waitcnt lgkmcnt(10)
    v_mfma_f32_16x16x32_bf16 v[96:99], a[48:51], a[0:3], v[96:99]
    ds_read_b64_tr_b16 a[40:41], v13 offset:0
    ds_read_b64_tr_b16 a[42:43], v13 offset:8192
    s_waitcnt lgkmcnt(10)
    v_mfma_f32_16x16x32_bf16 v[96:99], a[52:55], a[16:19], v[96:99]
    ds_read_b64_tr_b16 a[44:45], v13 offset:16384
    ds_read_b64_tr_b16 a[46:47], v13 offset:24576
    v_mfma_f32_16x16x32_bf16 v[100:103], a[48:51], a[4:7], v[100:103]
    s_add_u32 m0, s43, 57344
    v_mfma_f32_16x16x32_bf16 v[100:103], a[52:55], a[20:23], v[100:103]
    v_mfma_f32_16x16x32_bf16 v[104:107], a[48:51], a[8:11], v[104:107]
    v_mfma_f32_16x16x32_bf16 v[104:107], a[52:55], a[24:27], v[104:107]
    v_mfma_f32_16x16x32_bf16 v[108:111], a[48:51], a[12:15], v[108:111]
    buffer_load_dwordx4 v17, s[20:23], s41 offen nt lds
    v_mfma_f32_16x16x32_bf16 v[108:111], a[52:55], a[28:31], v[108:111]
    s_waitcnt lgkmcnt(10)
    v_mfma_f32_16x16x32_bf16 v[112:115], a[56:59], a[0:3], v[112:115]
    ds_read_b64_tr_b16 a[48:49], v14 offset:0
    ds_read_b64_tr_b16 a[50:51], v14 offset:8192
    s_waitcnt lgkmcnt(10)
    v_mfma_f32_16x16x32_bf16 v[112:115], a[60:63], a[16:19], v[112:115]
    ds_read_b64_tr_b16 a[52:53], v14 offset:16384
    ds_read_b64_tr_b16 a[54:55], v14 offset:24576
    v_mfma_f32_16x16x32_bf16 v[116:119], a[56:59], a[4:7], v[116:119]
    v_mfma_f32_16x16x32_bf16 v[116:119], a[60:63], a[20:23], v[116:119]
    buffer_load_dwordx4 v18, s[20:23], s41 offen offset:1024 nt lds
    v_mfma_f32_16x16x32_bf16 v[120:123], a[56:59], a[8:11], v[120:123]
    v_mfma_f32_16x16x32_bf16 v[120:123], a[60:63], a[24:27], v[120:123]
    v_mfma_f32_16x16x32_bf16 v[124:127], a[56:59], a[12:15], v[124:127]
    v_mfma_f32_16x16x32_bf16 v[124:127], a[60:63], a[28:31], v[124:127]
    s_add_u32 s41, s41, 8192
    s_waitcnt lgkmcnt(10)
    v_mfma_f32_16x16x32_bf16 v[128:131], a[32:35], a[0:3], v[128:131]
    ds_read_b64_tr_b16 a[56:57], v15 offset:0
    ds_read_b64_tr_b16 a[58:59], v15 offset:8192
    s_waitcnt lgkmcnt(10)
    v_mfma_f32_16x16x32_bf16 v[128:131], a[36:39], a[16:19], v[128:131]
    ds_read_b64_tr_b16 a[60:61], v15 offset:16384
    ds_read_b64_tr_b16 a[62:63], v15 offset:24576
    v_mfma_f32_16x16x32_bf16 v[132:135], a[32:35], a[4:7], v[132:135]
    v_mfma_f32_16x16x32_bf16 v[132:135], a[36:39], a[20:23], v[132:135]
    v_mfma_f32_16x16x32_bf16 v[136:139], a[32:35], a[8:11], v[136:139]
    v_mfma_f32_16x16x32_bf16 v[136:139], a[36:39], a[24:27], v[136:139]
    v_mfma_f32_16x16x32_bf16 v[140:143], a[32:35], a[12:15], v[140:143]
    v_mfma_f32_16x16x32_bf16 v[140:143], a[36:39], a[28:31], v[140:143]
    s_waitcnt vmcnt(16) lgkmcnt(0)
    s_barrier
    s_setprio 3
    v_mfma_f32_16x16x32_bf16 v[144:147], a[40:43], a[0:3], v[144:147]
    v_mfma_f32_16x16x32_bf16 v[144:147], a[44:47], a[16:19], v[144:147]
    v_mfma_f32_16x16x32_bf16 v[148:151], a[40:43], a[4:7], v[148:151]
    v_mfma_f32_16x16x32_bf16 v[148:151], a[44:47], a[20:23], v[148:151]
    v_mfma_f32_16x16x32_bf16 v[152:155], a[40:43], a[8:11], v[152:155]
    v_mfma_f32_16x16x32_bf16 v[152:155], a[44:47], a[24:27], v[152:155]
    v_mfma_f32_16x16x32_bf16 v[156:159], a[40:43], a[12:15], v[156:159]
    v_mfma_f32_16x16x32_bf16 v[156:159], a[44:47], a[28:31], v[156:159]
    v_mfma_f32_16x16x32_bf16 v[160:163], a[48:51], a[0:3], v[160:163]
    v_mfma_f32_16x16x32_bf16 v[160:163], a[52:55], a[16:19], v[160:163]
    v_mfma_f32_16x16x32_bf16 v[164:167], a[48:51], a[4:7], v[164:167]
    v_mfma_f32_16x16x32_bf16 v[164:167], a[52:55], a[20:23], v[164:167]
    v_mfma_f32_16x16x32_bf16 v[168:171], a[48:51], a[8:11], v[168:171]
    v_mfma_f32_16x16x32_bf16 v[168:171], a[52:55], a[24:27], v[168:171]
    v_mfma_f32_16x16x32_bf16 v[172:175], a[48:51], a[12:15], v[172:175]
    v_mfma_f32_16x16x32_bf16 v[172:175], a[52:55], a[28:31], v[172:175]
    s_add_u32 m0, s44, 0
    v_mfma_f32_16x16x32_bf16 v[176:179], a[56:59], a[0:3], v[176:179]
    buffer_load_dwordx4 v19, s[24:27], s42 offen nt lds
    v_mfma_f32_16x16x32_bf16 v[176:179], a[60:63], a[16:19], v[176:179]
    v_mfma_f32_16x16x32_bf16 v[180:183], a[56:59], a[4:7], v[180:183]
    v_mfma_f32_16x16x32_bf16 v[180:183], a[60:63], a[20:23], v[180:183]
    v_mfma_f32_16x16x32_bf16 v[184:187], a[56:59], a[8:11], v[184:187]
    buffer_load_dwordx4 v20, s[24:27], s42 offen offset:1024 nt lds
    s_add_u32 s42, s42, 8192
    v_mfma_f32_16x16x32_bf16 v[184:187], a[60:63], a[24:27], v[184:187]
    v_mfma_f32_16x16x32_bf16 v[188:191], a[56:59], a[12:15], v[188:191]
    v_mfma_f32_16x16x32_bf16 v[188:191], a[60:63], a[28:31], v[188:191]
    s_setprio 1
    s_add_u32 m0, s44, 8192
    s_nop 0
    buffer_load_dwordx4 v19, s[24:27], s42 offen nt lds
    buffer_load_dwordx4 v20, s[24:27], s42 offen offset:1024 nt lds
    s_add_u32 s42, s42, 8192
    s_add_u32 m0, s44, 16384
    s_nop 0
    buffer_load_dwordx4 v19, s[24:27], s42 offen nt lds
    buffer_load_dwordx4 v20, s[24:27], s42 offen offset:1024 nt lds
    s_add_u32 s42, s42, 8192
    s_add_u32 m0, s44, 24576
    s_nop 0
    buffer_load_dwordx4 v19, s[24:27], s42 offen nt lds
    buffer_load_dwordx4 v20, s[24:27], s42 offen offset:1024 nt lds
    s_add_u32 s42, s42, 8192
    s_waitcnt vmcnt(16)
    s_barrier
    ds_read_b64_tr_b16 a[32:33], v8 offset:32768
    ds_read_b64_tr_b16 a[34:35], v8 offset:40960
    ds_read_b64_tr_b16 a[36:37], v8 offset:49152
    ds_read_b64_tr_b16 a[38:39], v8 offset:57344
    ds_read_b128 a[0:3], v16 offset:0
    ds_read_b128 a[16:19], v16 offset:4096
    ds_read_b128 a[4:7], v16 offset:1024
    ds_read_b128 a[20:23], v16 offset:5120
    ds_read_b128 a[8:11], v16 offset:2048
    ds_read_b128 a[24:27], v16 offset:6144
    ds_read_b128 a[12:15], v16 offset:3072
    ds_read_b128 a[28:31], v16 offset:7168
    s_add_u32 m0, s43, 0
    s_nop 0
    buffer_load_dwordx4 v17, s[20:23], s41 offen nt lds
    buffer_load_dwordx4 v18, s[20:23], s41 offen offset:1024 nt lds
    s_add_u32 s41, s41, 8192
    s_add_u32 m0, s43, 8192
    s_nop 0
    buffer_load_dwordx4 v17, s[20:23], s41 offen nt lds
    buffer_load_dwordx4 v18, s[20:23], s41 offen offset:1024 nt lds
    s_add_u32 s41, s41, 8192
    s_setprio 1
    s_waitcnt lgkmcnt(7)
    v_mfma_f32_16x16x32_bf16 v[64:67], a[32:35], a[0:3], v[64:67]
    ds_read_b64_tr_b16 a[40:41], v9 offset:32768
    ds_read_b64_tr_b16 a[42:43], v9 offset:40960
    s_waitcnt lgkmcnt(8)
    v_mfma_f32_16x16x32_bf16 v[64:67], a[36:39], a[16:19], v[64:67]
    ds_read_b64_tr_b16 a[44:45], v9 offset:49152
    ds_read_b64_tr_b16 a[46:47], v9 offset:57344
    s_waitcnt lgkmcnt(9)
    v_mfma_f32_16x16x32_bf16 v[68:71], a[32:35], a[4:7], v[68:71]
    ds_read_b64_tr_b16 a[48:49], v10 offset:32768
    ds_read_b64_tr_b16 a[50:51], v10 offset:40960
    s_waitcnt lgkmcnt(10)
    v_mfma_f32_16x16x32_bf16 v[68:71], a[36:39], a[20:23], v[68:71]
    ds_read_b64_tr_b16 a[52:53], v10 offset:49152
    ds_read_b64_tr_b16 a[54:55], v10 offset:57344
    s_waitcnt lgkmcnt(11)
    v_mfma_f32_16x16x32_bf16 v[72:75], a[32:35], a[8:11], v[72:75]
    ds_read_b64_tr_b16 a[56:57], v11 offset:32768
    ds_read_b64_tr_b16 a[58:59], v11 offset:40960
    s_waitcnt lgkmcnt(12)
    v_mfma_f32_16x16x32_bf16 v[72:75], a[36:39], a[24:27], v[72:75]
    ds_read_b64_tr_b16 a[60:61], v11 offset:49152
    s_add_u32 m0, s43, 16384
    s_waitcnt lgkmcnt(12)
    v_mfma_f32_16x16x32_bf16 v[76:79], a[32:35], a[12:15], v[76:79]
    ds_read_b64_tr_b16 a[62:63], v11 offset:57344
    buffer_load_dwordx4 v17, s[20:23], s41 offen nt lds
    s_waitcnt lgkmcnt(12)
    v_mfma_f32_16x16x32_bf16 v[76:79], a[36:39], a[28:31], v[76:79]
    s_waitcnt lgkmcnt(10)
    v_mfma_f32_16x16x32_bf16 v[80:83], a[40:43], a[0:3], v[80:83]
    ds_read_b64_tr_b16 a[32:33], v12 offset:32768
    ds_read_b64_tr_b16 a[34:35], v12 offset:40960
    s_waitcnt lgkmcnt(10)
    v_mfma_f32_16x16x32_bf16 v[80:83], a[44:47], a[16:19], v[80:83]
    ds_read_b64_tr_b16 a[36:37], v12 offset:49152
    ds_read_b64_tr_b16 a[38:39], v12 offset:57344
    v_mfma_f32_16x16x32_bf16 v[84:87], a[40:43], a[4:7], v[84:87]
    buffer_load_dwordx4 v18, s[20:23], s41 offen offset:1024 nt lds
    v_mfma_f32_16x16x32_bf16 v[84:87], a[44:47], a[20:23], v[84:87]
    v_mfma_f32_16x16x32_bf16 v[88:91], a[40:43], a[8:11], v[88:91]
    v_mfma_f32_16x16x32_bf16 v[88:91], a[44:47], a[24:27], v[88:91]
    s_add_u32 s41, s41, 8192
    v_mfma_f32_16x16x32_bf16 v[92:95], a[40:43], a[12:15], v[92:95]
    v_mfma_f32_16x16x32_bf16 v[92:95], a[44:47], a[28:31], v[92:95]
    s_waitcnt lgkmcnt(10)
    v_mfma_f32_16x16x32_bf16 v[96:99], a[48:51], a[0:3], v[96:99]
    ds_read_b64_tr_b16 a[40:41], v13 offset:32768
    ds_read_b64_tr_b16 a[42:43], v13 offset:40960
    s_waitcnt lgkmcnt(10)
    v_mfma_f32_16x16x32_bf16 v[96:99], a[52:55], a[16:19], v[96:99]
    ds_read_b64_tr_b16 a[44:45], v13 offset:49152
    ds_read_b64_tr_b16 a[46:47], v13 offset:57344
    v_mfma_f32_16x16x32_bf16 v[100:103], a[48:51], a[4:7], v[100:103]
    s_add_u32 m0, s43, 24576
    v_mfma_f32_16x16x32_bf16 v[100:103], a[52:55], a[20:23], v[100:103]
    v_mfma_f32_16x16x32_bf16 v[104:107], a[48:51], a[8:11], v[104:107]
    v_mfma_f32_16x16x32_bf16 v[104:107], a[52:55], a[24:27], v[104:107]
    v_mfma_f32_16x16x32_bf16 v[108:111], a[48:51], a[12:15], v[108:111]
    buffer_load_dwordx4 v17, s[20:23], s41 offen nt lds
    v_mfma_f32_16x16x32_bf16 v[108:111], a[52:55], a[28:31], v[108:111]
    s_waitcnt lgkmcnt(10)
    v_mfma_f32_16x16x32_bf16 v[112:115], a[56:59], a[0:3], v[112:115]
    ds_read_b64_tr_b16 a[48:49], v14 offset:32768
    ds_read_b64_tr_b16 a[50:51], v14 offset:40960
    s_waitcnt lgkmcnt(10)
    v_mfma_f32_16x16x32_bf16 v[112:115], a[60:63], a[16:19], v[112:115]
    ds_read_b64_tr_b16 a[52:53], v14 offset:49152
    ds_read_b64_tr_b16 a[54:55], v14 offset:57344
    v_mfma_f32_16x16x32_bf16 v[116:119], a[56:59], a[4:7], v[116:119]
    v_mfma_f32_16x16x32_bf16 v[116:119], a[60:63], a[20:23], v[116:119]
    buffer_load_dwordx4 v18, s[20:23], s41 offen offset:1024 nt lds
    v_mfma_f32_16x16x32_bf16 v[120:123], a[56:59], a[8:11], v[120:123]
    v_mfma_f32_16x16x32_bf16 v[120:123], a[60:63], a[24:27], v[120:123]
    v_mfma_f32_16x16x32_bf16 v[124:127], a[56:59], a[12:15], v[124:127]
    v_mfma_f32_16x16x32_bf16 v[124:127], a[60:63], a[28:31], v[124:127]
    s_add_u32 s41, s41, 8192
    s_waitcnt lgkmcnt(10)
    v_mfma_f32_16x16x32_bf16 v[128:131], a[32:35], a[0:3], v[128:131]
    ds_read_b64_tr_b16 a[56:57], v15 offset:32768
    ds_read_b64_tr_b16 a[58:59], v15 offset:40960
    s_waitcnt lgkmcnt(10)
    v_mfma_f32_16x16x32_bf16 v[128:131], a[36:39], a[16:19], v[128:131]
    ds_read_b64_tr_b16 a[60:61], v15 offset:49152
    ds_read_b64_tr_b16 a[62:63], v15 offset:57344
    v_mfma_f32_16x16x32_bf16 v[132:135], a[32:35], a[4:7], v[132:135]
    v_mfma_f32_16x16x32_bf16 v[132:135], a[36:39], a[20:23], v[132:135]
    v_mfma_f32_16x16x32_bf16 v[136:139], a[32:35], a[8:11], v[136:139]
    v_mfma_f32_16x16x32_bf16 v[136:139], a[36:39], a[24:27], v[136:139]
    v_mfma_f32_16x16x32_bf16 v[140:143], a[32:35], a[12:15], v[140:143]
    v_mfma_f32_16x16x32_bf16 v[140:143], a[36:39], a[28:31], v[140:143]
    s_waitcnt vmcnt(16) lgkmcnt(0)
    s_barrier
    s_sub_u32 s40, s40, 1
    s_cmp_lg_u32 s40, 0
    s_cbranch_scc1 L_pv_loop
    s_setprio 3
    v_mfma_f32_16x16x32_bf16 v[144:147], a[40:43], a[0:3], v[144:147]
    v_mfma_f32_16x16x32_bf16 v[144:147], a[44:47], a[16:19], v[144:147]
    v_mfma_f32_16x16x32_bf16 v[148:151], a[40:43], a[4:7], v[148:151]
    v_mfma_f32_16x16x32_bf16 v[148:151], a[44:47], a[20:23], v[148:151]
    v_mfma_f32_16x16x32_bf16 v[152:155], a[40:43], a[8:11], v[152:155]
    v_mfma_f32_16x16x32_bf16 v[152:155], a[44:47], a[24:27], v[152:155]
    v_mfma_f32_16x16x32_bf16 v[156:159], a[40:43], a[12:15], v[156:159]
    v_mfma_f32_16x16x32_bf16 v[156:159], a[44:47], a[28:31], v[156:159]
    v_mfma_f32_16x16x32_bf16 v[160:163], a[48:51], a[0:3], v[160:163]
    v_mfma_f32_16x16x32_bf16 v[160:163], a[52:55], a[16:19], v[160:163]
    v_mfma_f32_16x16x32_bf16 v[164:167], a[48:51], a[4:7], v[164:167]
    v_mfma_f32_16x16x32_bf16 v[164:167], a[52:55], a[20:23], v[164:167]
    v_mfma_f32_16x16x32_bf16 v[168:171], a[48:51], a[8:11], v[168:171]
    v_mfma_f32_16x16x32_bf16 v[168:171], a[52:55], a[24:27], v[168:171]
    v_mfma_f32_16x16x32_bf16 v[172:175], a[48:51], a[12:15], v[172:175]
    v_mfma_f32_16x16x32_bf16 v[172:175], a[52:55], a[28:31], v[172:175]
    s_add_u32 m0, s44, 32768
    v_mfma_f32_16x16x32_bf16 v[176:179], a[56:59], a[0:3], v[176:179]
    buffer_load_dwordx4 v19, s[24:27], s42 offen nt lds
    v_mfma_f32_16x16x32_bf16 v[176:179], a[60:63], a[16:19], v[176:179]
    v_mfma_f32_16x16x32_bf16 v[180:183], a[56:59], a[4:7], v[180:183]
    v_mfma_f32_16x16x32_bf16 v[180:183], a[60:63], a[20:23], v[180:183]
    v_mfma_f32_16x16x32_bf16 v[184:187], a[56:59], a[8:11], v[184:187]
    buffer_load_dwordx4 v20, s[24:27], s42 offen offset:1024 nt lds
    s_add_u32 s42, s42, 8192
    v_mfma_f32_16x16x32_bf16 v[184:187], a[60:63], a[24:27], v[184:187]
    v_mfma_f32_16x16x32_bf16 v[188:191], a[56:59], a[12:15], v[188:191]
    v_mfma_f32_16x16x32_bf16 v[188:191], a[60:63], a[28:31], v[188:191]
    s_setprio 1
    s_add_u32 m0, s44, 40960
    s_nop 0
    buffer_load_dwordx4 v19, s[24:27], s42 offen nt lds
    buffer_load_dwordx4 v20, s[24:27], s42 offen offset:1024 nt lds
    s_add_u32 s42, s42, 8192
    s_add_u32 m0, s44, 49152
    s_nop 0
    buffer_load_dwordx4 v19, s[24:27], s42 offen nt lds
    buffer_load_dwordx4 v20, s[24:27], s42 offen offset:1024 nt lds
    s_add_u32 s42, s42, 8192
    s_add_u32 m0, s44, 57344
    s_nop 0
    buffer_load_dwordx4 v19, s[24:27], s42 offen nt lds
    buffer_load_dwordx4 v20, s[24:27], s42 offen offset:1024 nt lds
    s_add_u32 s42, s42, 8192
    s_waitcnt vmcnt(16)
    s_barrier
    ds_read_b64_tr_b16 a[32:33], v8 offset:0
    ds_read_b64_tr_b16 a[34:35], v8 offset:8192
    ds_read_b64_tr_b16 a[36:37], v8 offset:16384
    ds_read_b64_tr_b16 a[38:39], v8 offset:24576
    ds_read_b128 a[0:3], v16 offset:0
    ds_read_b128 a[16:19], v16 offset:4096
    ds_read_b128 a[4:7], v16 offset:1024
    ds_read_b128 a[20:23], v16 offset:5120
    ds_read_b128 a[8:11], v16 offset:2048
    ds_read_b128 a[24:27], v16 offset:6144
    ds_read_b128 a[12:15], v16 offset:3072
    ds_read_b128 a[28:31], v16 offset:7168
    s_add_u32 m0, s43, 32768
    s_nop 0
    buffer_load_dwordx4 v17, s[20:23], s41 offen nt lds
    buffer_load_dwordx4 v18, s[20:23], s41 offen offset:1024 nt lds
    s_add_u32 s41, s41, 8192
    s_add_u32 m0, s43, 40960
    s_nop 0
    buffer_load_dwordx4 v17, s[20:23], s41 offen nt lds
    buffer_load_dwordx4 v18, s[20:23], s41 offen offset:1024 nt lds
    s_add_u32 s41, s41, 8192
    s_setprio 1
    s_waitcnt lgkmcnt(7)
    v_mfma_f32_16x16x32_bf16 v[64:67], a[32:35], a[0:3], v[64:67]
    ds_read_b64_tr_b16 a[40:41], v9 offset:0
    ds_read_b64_tr_b16 a[42:43], v9 offset:8192
    s_waitcnt lgkmcnt(8)
    v_mfma_f32_16x16x32_bf16 v[64:67], a[36:39], a[16:19], v[64:67]
    ds_read_b64_tr_b16 a[44:45], v9 offset:16384
    ds_read_b64_tr_b16 a[46:47], v9 offset:24576
    s_waitcnt lgkmcnt(9)
    v_mfma_f32_16x16x32_bf16 v[68:71], a[32:35], a[4:7], v[68:71]
    ds_read_b64_tr_b16 a[48:49], v10 offset:0
    ds_read_b64_tr_b16 a[50:51], v10 offset:8192
    s_waitcnt lgkmcnt(10)
    v_mfma_f32_16x16x32_bf16 v[68:71], a[36:39], a[20:23], v[68:71]
    ds_read_b64_tr_b16 a[52:53], v10 offset:16384
    ds_read_b64_tr_b16 a[54:55], v10 offset:24576
    s_waitcnt lgkmcnt(11)
    v_mfma_f32_16x16x32_bf16 v[72:75], a[32:35], a[8:11], v[72:75]
    ds_read_b64_tr_b16 a[56:57], v11 offset:0
    ds_read_b64_tr_b16 a[58:59], v11 offset:8192
    s_waitcnt lgkmcnt(12)
    v_mfma_f32_16x16x32_bf16 v[72:75], a[36:39], a[24:27], v[72:75]
    ds_read_b64_tr_b16 a[60:61], v11 offset:16384
    s_add_u32 m0, s43, 49152
    s_waitcnt lgkmcnt(12)
    v_mfma_f32_16x16x32_bf16 v[76:79], a[32:35], a[12:15], v[76:79]
    ds_read_b64_tr_b16 a[62:63], v11 offset:24576
    buffer_load_dwordx4 v17, s[20:23], s41 offen nt lds
    s_waitcnt lgkmcnt(12)
    v_mfma_f32_16x16x32_bf16 v[76:79], a[36:39], a[28:31], v[76:79]
    s_waitcnt lgkmcnt(10)
    v_mfma_f32_16x16x32_bf16 v[80:83], a[40:43], a[0:3], v[80:83]
    ds_read_b64_tr_b16 a[32:33], v12 offset:0
    ds_read_b64_tr_b16 a[34:35], v12 offset:8192
    s_waitcnt lgkmcnt(10)
    v_mfma_f32_16x16x32_bf16 v[80:83], a[44:47], a[16:19], v[80:83]
    ds_read_b64_tr_b16 a[36:37], v12 offset:16384
    ds_read_b64_tr_b16 a[38:39], v12 offset:24576
    v_mfma_f32_16x16x32_bf16 v[84:87], a[40:43], a[4:7], v[84:87]
    buffer_load_dwordx4 v18, s[20:23], s41 offen offset:1024 nt lds
    v_mfma_f32_16x16x32_bf16 v[84:87], a[44:47], a[20:23], v[84:87]
    v_mfma_f32_16x16x32_bf16 v[88:91], a[40:43], a[8:11], v[88:91]
    v_mfma_f32_16x16x32_bf16 v[88:91], a[44:47], a[24:27], v[88:91]
    s_add_u32 s41, s41, 8192
    v_mfma_f32_16x16x32_bf16 v[92:95], a[40:43], a[12:15], v[92:95]
    v_mfma_f32_16x16x32_bf16 v[92:95], a[44:47], a[28:31], v[92:95]
    s_waitcnt lgkmcnt(10)
    v_mfma_f32_16x16x32_bf16 v[96:99], a[48:51], a[0:3], v[96:99]
    ds_read_b64_tr_b16 a[40:41], v13 offset:0
    ds_read_b64_tr_b16 a[42:43], v13 offset:8192
    s_waitcnt lgkmcnt(10)
    v_mfma_f32_16x16x32_bf16 v[96:99], a[52:55], a[16:19], v[96:99]
    ds_read_b64_tr_b16 a[44:45], v13 offset:16384
    ds_read_b64_tr_b16 a[46:47], v13 offset:24576
    v_mfma_f32_16x16x32_bf16 v[100:103], a[48:51], a[4:7], v[100:103]
    s_add_u32 m0, s43, 57344
    v_mfma_f32_16x16x32_bf16 v[100:103], a[52:55], a[20:23], v[100:103]
    v_mfma_f32_16x16x32_bf16 v[104:107], a[48:51], a[8:11], v[104:107]
    v_mfma_f32_16x16x32_bf16 v[104:107], a[52:55], a[24:27], v[104:107]
    v_mfma_f32_16x16x32_bf16 v[108:111], a[48:51], a[12:15], v[108:111]
    buffer_load_dwordx4 v17, s[20:23], s41 offen nt lds
    v_mfma_f32_16x16x32_bf16 v[108:111], a[52:55], a[28:31], v[108:111]
    s_waitcnt lgkmcnt(10)
    v_mfma_f32_16x16x32_bf16 v[112:115], a[56:59], a[0:3], v[112:115]
    ds_read_b64_tr_b16 a[48:49], v14 offset:0
    ds_read_b64_tr_b16 a[50:51], v14 offset:8192
    s_waitcnt lgkmcnt(10)
    v_mfma_f32_16x16x32_bf16 v[112:115], a[60:63], a[16:19], v[112:115]
    ds_read_b64_tr_b16 a[52:53], v14 offset:16384
    ds_read_b64_tr_b16 a[54:55], v14 offset:24576
    v_mfma_f32_16x16x32_bf16 v[116:119], a[56:59], a[4:7], v[116:119]
    v_mfma_f32_16x16x32_bf16 v[116:119], a[60:63], a[20:23], v[116:119]
    buffer_load_dwordx4 v18, s[20:23], s41 offen offset:1024 nt lds
    v_mfma_f32_16x16x32_bf16 v[120:123], a[56:59], a[8:11], v[120:123]
    v_mfma_f32_16x16x32_bf16 v[120:123], a[60:63], a[24:27], v[120:123]
    v_mfma_f32_16x16x32_bf16 v[124:127], a[56:59], a[12:15], v[124:127]
    v_mfma_f32_16x16x32_bf16 v[124:127], a[60:63], a[28:31], v[124:127]
    s_add_u32 s41, s41, 8192
    s_waitcnt lgkmcnt(10)
    v_mfma_f32_16x16x32_bf16 v[128:131], a[32:35], a[0:3], v[128:131]
    ds_read_b64_tr_b16 a[56:57], v15 offset:0
    ds_read_b64_tr_b16 a[58:59], v15 offset:8192
    s_waitcnt lgkmcnt(10)
    v_mfma_f32_16x16x32_bf16 v[128:131], a[36:39], a[16:19], v[128:131]
    ds_read_b64_tr_b16 a[60:61], v15 offset:16384
    ds_read_b64_tr_b16 a[62:63], v15 offset:24576
    v_mfma_f32_16x16x32_bf16 v[132:135], a[32:35], a[4:7], v[132:135]
    v_mfma_f32_16x16x32_bf16 v[132:135], a[36:39], a[20:23], v[132:135]
    v_mfma_f32_16x16x32_bf16 v[136:139], a[32:35], a[8:11], v[136:139]
    v_mfma_f32_16x16x32_bf16 v[136:139], a[36:39], a[24:27], v[136:139]
    v_mfma_f32_16x16x32_bf16 v[140:143], a[32:35], a[12:15], v[140:143]
    v_mfma_f32_16x16x32_bf16 v[140:143], a[36:39], a[28:31], v[140:143]
    s_waitcnt vmcnt(16) lgkmcnt(0)
    s_barrier
    s_setprio 3
    v_mfma_f32_16x16x32_bf16 v[144:147], a[40:43], a[0:3], v[144:147]
    v_mfma_f32_16x16x32_bf16 v[144:147], a[44:47], a[16:19], v[144:147]
    v_mfma_f32_16x16x32_bf16 v[148:151], a[40:43], a[4:7], v[148:151]
    v_mfma_f32_16x16x32_bf16 v[148:151], a[44:47], a[20:23], v[148:151]
    v_mfma_f32_16x16x32_bf16 v[152:155], a[40:43], a[8:11], v[152:155]
    v_mfma_f32_16x16x32_bf16 v[152:155], a[44:47], a[24:27], v[152:155]
    v_mfma_f32_16x16x32_bf16 v[156:159], a[40:43], a[12:15], v[156:159]
    v_mfma_f32_16x16x32_bf16 v[156:159], a[44:47], a[28:31], v[156:159]
    v_mfma_f32_16x16x32_bf16 v[160:163], a[48:51], a[0:3], v[160:163]
    v_mfma_f32_16x16x32_bf16 v[160:163], a[52:55], a[16:19], v[160:163]
    v_mfma_f32_16x16x32_bf16 v[164:167], a[48:51], a[4:7], v[164:167]
    v_mfma_f32_16x16x32_bf16 v[164:167], a[52:55], a[20:23], v[164:167]
    v_mfma_f32_16x16x32_bf16 v[168:171], a[48:51], a[8:11], v[168:171]
    v_mfma_f32_16x16x32_bf16 v[168:171], a[52:55], a[24:27], v[168:171]
    v_mfma_f32_16x16x32_bf16 v[172:175], a[48:51], a[12:15], v[172:175]
    v_mfma_f32_16x16x32_bf16 v[172:175], a[52:55], a[28:31], v[172:175]
    s_add_u32 m0, s44, 0
    v_mfma_f32_16x16x32_bf16 v[176:179], a[56:59], a[0:3], v[176:179]
    buffer_load_dwordx4 v19, s[24:27], s42 offen nt lds
    v_mfma_f32_16x16x32_bf16 v[176:179], a[60:63], a[16:19], v[176:179]
    v_mfma_f32_16x16x32_bf16 v[180:183], a[56:59], a[4:7], v[180:183]
    v_mfma_f32_16x16x32_bf16 v[180:183], a[60:63], a[20:23], v[180:183]
    v_mfma_f32_16x16x32_bf16 v[184:187], a[56:59], a[8:11], v[184:187]
    buffer_load_dwordx4 v20, s[24:27], s42 offen offset:1024 nt lds
    s_add_u32 s42, s42, 8192
    v_mfma_f32_16x16x32_bf16 v[184:187], a[60:63], a[24:27], v[184:187]
    v_mfma_f32_16x16x32_bf16 v[188:191], a[56:59], a[12:15], v[188:191]
    v_mfma_f32_16x16x32_bf16 v[188:191], a[60:63], a[28:31], v[188:191]
    s_setprio 1
    s_add_u32 m0, s44, 8192
    s_nop 0
    buffer_load_dwordx4 v19, s[24:27], s42 offen nt lds
    buffer_load_dwordx4 v20, s[24:27], s42 offen offset:1024 nt lds
    s_add_u32 s42, s42, 8192
    s_add_u32 m0, s44, 16384
    s_nop 0
    buffer_load_dwordx4 v19, s[24:27], s42 offen nt lds
    buffer_load_dwordx4 v20, s[24:27], s42 offen offset:1024 nt lds
    s_add_u32 s42, s42, 8192
    s_add_u32 m0, s44, 24576
    s_nop 0
    buffer_load_dwordx4 v19, s[24:27], s42 offen nt lds
    buffer_load_dwordx4 v20, s[24:27], s42 offen offset:1024 nt lds
    s_add_u32 s42, s42, 8192
    s_waitcnt vmcnt(16)
    s_barrier
    ds_read_b64_tr_b16 a[32:33], v8 offset:32768
    ds_read_b64_tr_b16 a[34:35], v8 offset:40960
    ds_read_b64_tr_b16 a[36:37], v8 offset:49152
    ds_read_b64_tr_b16 a[38:39], v8 offset:57344
    ds_read_b128 a[0:3], v16 offset:0
    ds_read_b128 a[16:19], v16 offset:4096
    ds_read_b128 a[4:7], v16 offset:1024
    ds_read_b128 a[20:23], v16 offset:5120
    ds_read_b128 a[8:11], v16 offset:2048
    ds_read_b128 a[24:27], v16 offset:6144
    ds_read_b128 a[12:15], v16 offset:3072
    ds_read_b128 a[28:31], v16 offset:7168
    s_setprio 1
    s_waitcnt lgkmcnt(7)
    v_mfma_f32_16x16x32_bf16 v[64:67], a[32:35], a[0:3], v[64:67]
    ds_read_b64_tr_b16 a[40:41], v9 offset:32768
    ds_read_b64_tr_b16 a[42:43], v9 offset:40960
    s_waitcnt lgkmcnt(8)
    v_mfma_f32_16x16x32_bf16 v[64:67], a[36:39], a[16:19], v[64:67]
    ds_read_b64_tr_b16 a[44:45], v9 offset:49152
    ds_read_b64_tr_b16 a[46:47], v9 offset:57344
    s_waitcnt lgkmcnt(9)
    v_mfma_f32_16x16x32_bf16 v[68:71], a[32:35], a[4:7], v[68:71]
    ds_read_b64_tr_b16 a[48:49], v10 offset:32768
    ds_read_b64_tr_b16 a[50:51], v10 offset:40960
    s_waitcnt lgkmcnt(10)
    v_mfma_f32_16x16x32_bf16 v[68:71], a[36:39], a[20:23], v[68:71]
    ds_read_b64_tr_b16 a[52:53], v10 offset:49152
    ds_read_b64_tr_b16 a[54:55], v10 offset:57344
    s_waitcnt lgkmcnt(11)
    v_mfma_f32_16x16x32_bf16 v[72:75], a[32:35], a[8:11], v[72:75]
    ds_read_b64_tr_b16 a[56:57], v11 offset:32768
    ds_read_b64_tr_b16 a[58:59], v11 offset:40960
    s_waitcnt lgkmcnt(12)
    v_mfma_f32_16x16x32_bf16 v[72:75], a[36:39], a[24:27], v[72:75]
    ds_read_b64_tr_b16 a[60:61], v11 offset:49152
    s_waitcnt lgkmcnt(12)
    v_mfma_f32_16x16x32_bf16 v[76:79], a[32:35], a[12:15], v[76:79]
    ds_read_b64_tr_b16 a[62:63], v11 offset:57344
    s_waitcnt lgkmcnt(12)
    v_mfma_f32_16x16x32_bf16 v[76:79], a[36:39], a[28:31], v[76:79]
    s_waitcnt lgkmcnt(10)
    v_mfma_f32_16x16x32_bf16 v[80:83], a[40:43], a[0:3], v[80:83]
    ds_read_b64_tr_b16 a[32:33], v12 offset:32768
    ds_read_b64_tr_b16 a[34:35], v12 offset:40960
    s_waitcnt lgkmcnt(10)
    v_mfma_f32_16x16x32_bf16 v[80:83], a[44:47], a[16:19], v[80:83]
    ds_read_b64_tr_b16 a[36:37], v12 offset:49152
    ds_read_b64_tr_b16 a[38:39], v12 offset:57344
    v_mfma_f32_16x16x32_bf16 v[84:87], a[40:43], a[4:7], v[84:87]
    v_mfma_f32_16x16x32_bf16 v[84:87], a[44:47], a[20:23], v[84:87]
    v_mfma_f32_16x16x32_bf16 v[88:91], a[40:43], a[8:11], v[88:91]
    v_mfma_f32_16x16x32_bf16 v[88:91], a[44:47], a[24:27], v[88:91]
    v_mfma_f32_16x16x32_bf16 v[92:95], a[40:43], a[12:15], v[92:95]
    v_mfma_f32_16x16x32_bf16 v[92:95], a[44:47], a[28:31], v[92:95]
    s_waitcnt lgkmcnt(10)
    v_mfma_f32_16x16x32_bf16 v[96:99], a[48:51], a[0:3], v[96:99]
    ds_read_b64_tr_b16 a[40:41], v13 offset:32768
    ds_read_b64_tr_b16 a[42:43], v13 offset:40960
    s_waitcnt lgkmcnt(10)
    v_mfma_f32_16x16x32_bf16 v[96:99], a[52:55], a[16:19], v[96:99]
    ds_read_b64_tr_b16 a[44:45], v13 offset:49152
    ds_read_b64_tr_b16 a[46:47], v13 offset:57344
    v_mfma_f32_16x16x32_bf16 v[100:103], a[48:51], a[4:7], v[100:103]
    v_mfma_f32_16x16x32_bf16 v[100:103], a[52:55], a[20:23], v[100:103]
    v_mfma_f32_16x16x32_bf16 v[104:107], a[48:51], a[8:11], v[104:107]
    v_mfma_f32_16x16x32_bf16 v[104:107], a[52:55], a[24:27], v[104:107]
    v_mfma_f32_16x16x32_bf16 v[108:111], a[48:51], a[12:15], v[108:111]
    v_mfma_f32_16x16x32_bf16 v[108:111], a[52:55], a[28:31], v[108:111]
    s_waitcnt lgkmcnt(10)
    v_mfma_f32_16x16x32_bf16 v[112:115], a[56:59], a[0:3], v[112:115]
    ds_read_b64_tr_b16 a[48:49], v14 offset:32768
    ds_read_b64_tr_b16 a[50:51], v14 offset:40960
    s_waitcnt lgkmcnt(10)
    v_mfma_f32_16x16x32_bf16 v[112:115], a[60:63], a[16:19], v[112:115]
    ds_read_b64_tr_b16 a[52:53], v14 offset:49152
    ds_read_b64_tr_b16 a[54:55], v14 offset:57344
    v_mfma_f32_16x16x32_bf16 v[116:119], a[56:59], a[4:7], v[116:119]
    v_mfma_f32_16x16x32_bf16 v[116:119], a[60:63], a[20:23], v[116:119]
    v_mfma_f32_16x16x32_bf16 v[120:123], a[56:59], a[8:11], v[120:123]
    v_mfma_f32_16x16x32_bf16 v[120:123], a[60:63], a[24:27], v[120:123]
    v_mfma_f32_16x16x32_bf16 v[124:127], a[56:59], a[12:15], v[124:127]
    v_mfma_f32_16x16x32_bf16 v[124:127], a[60:63], a[28:31], v[124:127]
    s_waitcnt lgkmcnt(10)
    v_mfma_f32_16x16x32_bf16 v[128:131], a[32:35], a[0:3], v[128:131]
    ds_read_b64_tr_b16 a[56:57], v15 offset:32768
    ds_read_b64_tr_b16 a[58:59], v15 offset:40960
    s_waitcnt lgkmcnt(10)
    v_mfma_f32_16x16x32_bf16 v[128:131], a[36:39], a[16:19], v[128:131]
    ds_read_b64_tr_b16 a[60:61], v15 offset:49152
    ds_read_b64_tr_b16 a[62:63], v15 offset:57344
    v_mfma_f32_16x16x32_bf16 v[132:135], a[32:35], a[4:7], v[132:135]
    v_mfma_f32_16x16x32_bf16 v[132:135], a[36:39], a[20:23], v[132:135]
    v_mfma_f32_16x16x32_bf16 v[136:139], a[32:35], a[8:11], v[136:139]
    v_mfma_f32_16x16x32_bf16 v[136:139], a[36:39], a[24:27], v[136:139]
    v_mfma_f32_16x16x32_bf16 v[140:143], a[32:35], a[12:15], v[140:143]
    v_mfma_f32_16x16x32_bf16 v[140:143], a[36:39], a[28:31], v[140:143]
    s_waitcnt vmcnt(8) lgkmcnt(0)
    s_barrier
    s_setprio 3
    v_mfma_f32_16x16x32_bf16 v[144:147], a[40:43], a[0:3], v[144:147]
    v_mfma_f32_16x16x32_bf16 v[144:147], a[44:47], a[16:19], v[144:147]
    v_mfma_f32_16x16x32_bf16 v[148:151], a[40:43], a[4:7], v[148:151]
    v_mfma_f32_16x16x32_bf16 v[148:151], a[44:47], a[20:23], v[148:151]
    v_mfma_f32_16x16x32_bf16 v[152:155], a[40:43], a[8:11], v[152:155]
    v_mfma_f32_16x16x32_bf16 v[152:155], a[44:47], a[24:27], v[152:155]
    v_mfma_f32_16x16x32_bf16 v[156:159], a[40:43], a[12:15], v[156:159]
    v_mfma_f32_16x16x32_bf16 v[156:159], a[44:47], a[28:31], v[156:159]
    v_mfma_f32_16x16x32_bf16 v[160:163], a[48:51], a[0:3], v[160:163]
    v_mfma_f32_16x16x32_bf16 v[160:163], a[52:55], a[16:19], v[160:163]
    v_mfma_f32_16x16x32_bf16 v[164:167], a[48:51], a[4:7], v[164:167]
    v_mfma_f32_16x16x32_bf16 v[164:167], a[52:55], a[20:23], v[164:167]
    v_mfma_f32_16x16x32_bf16 v[168:171], a[48:51], a[8:11], v[168:171]
    v_mfma_f32_16x16x32_bf16 v[168:171], a[52:55], a[24:27], v[168:171]
    v_mfma_f32_16x16x32_bf16 v[172:175], a[48:51], a[12:15], v[172:175]
    v_mfma_f32_16x16x32_bf16 v[172:175], a[52:55], a[28:31], v[172:175]
    s_add_u32 m0, s44, 32768
    v_mfma_f32_16x16x32_bf16 v[176:179], a[56:59], a[0:3], v[176:179]
    buffer_load_dwordx4 v19, s[24:27], s42 offen nt lds
    v_mfma_f32_16x16x32_bf16 v[176:179], a[60:63], a[16:19], v[176:179]
    v_mfma_f32_16x16x32_bf16 v[180:183], a[56:59], a[4:7], v[180:183]
    v_mfma_f32_16x16x32_bf16 v[180:183], a[60:63], a[20:23], v[180:183]
    v_mfma_f32_16x16x32_bf16 v[184:187], a[56:59], a[8:11], v[184:187]
    buffer_load_dwordx4 v20, s[24:27], s42 offen offset:1024 nt lds
    s_add_u32 s42, s42, 8192
    v_mfma_f32_16x16x32_bf16 v[184:187], a[60:63], a[24:27], v[184:187]
    v_mfma_f32_16x16x32_bf16 v[188:191], a[56:59], a[12:15], v[188:191]
    v_mfma_f32_16x16x32_bf16 v[188:191], a[60:63], a[28:31], v[188:191]
    s_setprio 1
    s_add_u32 m0, s44, 40960
    s_nop 0
    buffer_load_dwordx4 v19, s[24:27], s42 offen nt lds
    buffer_load_dwordx4 v20, s[24:27], s42 offen offset:1024 nt lds
    s_add_u32 s42, s42, 8192
    s_add_u32 m0, s44, 49152
    s_nop 0
    buffer_load_dwordx4 v19, s[24:27], s42 offen nt lds
    buffer_load_dwordx4 v20, s[24:27], s42 offen offset:1024 nt lds
    s_add_u32 s42, s42, 8192
    s_add_u32 m0, s44, 57344
    s_nop 0
    buffer_load_dwordx4 v19, s[24:27], s42 offen nt lds
    buffer_load_dwordx4 v20, s[24:27], s42 offen offset:1024 nt lds
    s_add_u32 s42, s42, 8192
    s_waitcnt vmcnt(8)
    s_barrier
    ds_read_b64_tr_b16 a[32:33], v8 offset:0
    ds_read_b64_tr_b16 a[34:35], v8 offset:8192
    ds_read_b64_tr_b16 a[36:37], v8 offset:16384
    ds_read_b64_tr_b16 a[38:39], v8 offset:24576
    ds_read_b128 a[0:3], v16 offset:0
    ds_read_b128 a[16:19], v16 offset:4096
    ds_read_b128 a[4:7], v16 offset:1024
    ds_read_b128 a[20:23], v16 offset:5120
    ds_read_b128 a[8:11], v16 offset:2048
    ds_read_b128 a[24:27], v16 offset:6144
    ds_read_b128 a[12:15], v16 offset:3072
    ds_read_b128 a[28:31], v16 offset:7168
    s_setprio 1
    s_waitcnt lgkmcnt(7)
    v_mfma_f32_16x16x32_bf16 v[64:67], a[32:35], a[0:3], v[64:67]
    ds_read_b64_tr_b16 a[40:41], v9 offset:0
    ds_read_b64_tr_b16 a[42:43], v9 offset:8192
    s_waitcnt lgkmcnt(8)
    v_mfma_f32_16x16x32_bf16 v[64:67], a[36:39], a[16:19], v[64:67]
    ds_read_b64_tr_b16 a[44:45], v9 offset:16384
    ds_read_b64_tr_b16 a[46:47], v9 offset:24576
    s_waitcnt lgkmcnt(9)
    v_mfma_f32_16x16x32_bf16 v[68:71], a[32:35], a[4:7], v[68:71]
    ds_read_b64_tr_b16 a[48:49], v10 offset:0
    ds_read_b64_tr_b16 a[50:51], v10 offset:8192
    s_waitcnt lgkmcnt(10)
    v_mfma_f32_16x16x32_bf16 v[68:71], a[36:39], a[20:23], v[68:71]
    ds_read_b64_tr_b16 a[52:53], v10 offset:16384
    ds_read_b64_tr_b16 a[54:55], v10 offset:24576
    s_waitcnt lgkmcnt(11)
    v_mfma_f32_16x16x32_bf16 v[72:75], a[32:35], a[8:11], v[72:75]
    ds_read_b64_tr_b16 a[56:57], v11 offset:0
    ds_read_b64_tr_b16 a[58:59], v11 offset:8192
    s_waitcnt lgkmcnt(12)
    v_mfma_f32_16x16x32_bf16 v[72:75], a[36:39], a[24:27], v[72:75]
    ds_read_b64_tr_b16 a[60:61], v11 offset:16384
    s_waitcnt lgkmcnt(12)
    v_mfma_f32_16x16x32_bf16 v[76:79], a[32:35], a[12:15], v[76:79]
    ds_read_b64_tr_b16 a[62:63], v11 offset:24576
    s_waitcnt lgkmcnt(12)
    v_mfma_f32_16x16x32_bf16 v[76:79], a[36:39], a[28:31], v[76:79]
    s_waitcnt lgkmcnt(10)
    v_mfma_f32_16x16x32_bf16 v[80:83], a[40:43], a[0:3], v[80:83]
    ds_read_b64_tr_b16 a[32:33], v12 offset:0
    ds_read_b64_tr_b16 a[34:35], v12 offset:8192
    s_waitcnt lgkmcnt(10)
    v_mfma_f32_16x16x32_bf16 v[80:83], a[44:47], a[16:19], v[80:83]
    ds_read_b64_tr_b16 a[36:37], v12 offset:16384
    ds_read_b64_tr_b16 a[38:39], v12 offset:24576
    v_mfma_f32_16x16x32_bf16 v[84:87], a[40:43], a[4:7], v[84:87]
    v_mfma_f32_16x16x32_bf16 v[84:87], a[44:47], a[20:23], v[84:87]
    v_mfma_f32_16x16x32_bf16 v[88:91], a[40:43], a[8:11], v[88:91]
    v_mfma_f32_16x16x32_bf16 v[88:91], a[44:47], a[24:27], v[88:91]
    v_mfma_f32_16x16x32_bf16 v[92:95], a[40:43], a[12:15], v[92:95]
    v_mfma_f32_16x16x32_bf16 v[92:95], a[44:47], a[28:31], v[92:95]
    s_waitcnt lgkmcnt(10)
    v_mfma_f32_16x16x32_bf16 v[96:99], a[48:51], a[0:3], v[96:99]
    ds_read_b64_tr_b16 a[40:41], v13 offset:0
    ds_read_b64_tr_b16 a[42:43], v13 offset:8192
    s_waitcnt lgkmcnt(10)
    v_mfma_f32_16x16x32_bf16 v[96:99], a[52:55], a[16:19], v[96:99]
    ds_read_b64_tr_b16 a[44:45], v13 offset:16384
    ds_read_b64_tr_b16 a[46:47], v13 offset:24576
    v_mfma_f32_16x16x32_bf16 v[100:103], a[48:51], a[4:7], v[100:103]
    v_mfma_f32_16x16x32_bf16 v[100:103], a[52:55], a[20:23], v[100:103]
    v_mfma_f32_16x16x32_bf16 v[104:107], a[48:51], a[8:11], v[104:107]
    v_mfma_f32_16x16x32_bf16 v[104:107], a[52:55], a[24:27], v[104:107]
    v_mfma_f32_16x16x32_bf16 v[108:111], a[48:51], a[12:15], v[108:111]
    v_mfma_f32_16x16x32_bf16 v[108:111], a[52:55], a[28:31], v[108:111]
    s_waitcnt lgkmcnt(10)
    v_mfma_f32_16x16x32_bf16 v[112:115], a[56:59], a[0:3], v[112:115]
    ds_read_b64_tr_b16 a[48:49], v14 offset:0
    ds_read_b64_tr_b16 a[50:51], v14 offset:8192
    s_waitcnt lgkmcnt(10)
    v_mfma_f32_16x16x32_bf16 v[112:115], a[60:63], a[16:19], v[112:115]
    ds_read_b64_tr_b16 a[52:53], v14 offset:16384
    ds_read_b64_tr_b16 a[54:55], v14 offset:24576
    v_mfma_f32_16x16x32_bf16 v[116:119], a[56:59], a[4:7], v[116:119]
    v_mfma_f32_16x16x32_bf16 v[116:119], a[60:63], a[20:23], v[116:119]
    v_mfma_f32_16x16x32_bf16 v[120:123], a[56:59], a[8:11], v[120:123]
    v_mfma_f32_16x16x32_bf16 v[120:123], a[60:63], a[24:27], v[120:123]
    v_mfma_f32_16x16x32_bf16 v[124:127], a[56:59], a[12:15], v[124:127]
    v_mfma_f32_16x16x32_bf16 v[124:127], a[60:63], a[28:31], v[124:127]
    s_waitcnt lgkmcnt(10)
    v_mfma_f32_16x16x32_bf16 v[128:131], a[32:35], a[0:3], v[128:131]
    ds_read_b64_tr_b16 a[56:57], v15 offset:0
    ds_read_b64_tr_b16 a[58:59], v15 offset:8192
    s_waitcnt lgkmcnt(10)
    v_mfma_f32_16x16x32_bf16 v[128:131], a[36:39], a[16:19], v[128:131]
    ds_read_b64_tr_b16 a[60:61], v15 offset:16384
    ds_read_b64_tr_b16 a[62:63], v15 offset:24576
    v_mfma_f32_16x16x32_bf16 v[132:135], a[32:35], a[4:7], v[132:135]
    v_mfma_f32_16x16x32_bf16 v[132:135], a[36:39], a[20:23], v[132:135]
    v_mfma_f32_16x16x32_bf16 v[136:139], a[32:35], a[8:11], v[136:139]
    v_mfma_f32_16x16x32_bf16 v[136:139], a[36:39], a[24:27], v[136:139]
    v_mfma_f32_16x16x32_bf16 v[140:143], a[32:35], a[12:15], v[140:143]
    v_mfma_f32_16x16x32_bf16 v[140:143], a[36:39], a[28:31], v[140:143]
    s_waitcnt vmcnt(8) lgkmcnt(0)
    s_barrier
    s_setprio 3
    s_and_b32 s48, s36, 1
    s_lshl_b32 s48, s48, 11
    s_add_u32 s48, s48, 147456
    v_lshlrev_b32 v21, 4, v2
    v_add_u32 v23, s48, v21
    v_and_b32 v22, 3, v2
    v_lshlrev_b32 v22, 6, v22
    v_add_u32 v22, 151552, v22
    v_mfma_f32_16x16x32_bf16 v[144:147], a[40:43], a[0:3], v[144:147]
    v_mfma_f32_16x16x32_bf16 v[144:147], a[44:47], a[16:19], v[144:147]
    v_mfma_f32_16x16x32_bf16 v[148:151], a[40:43], a[4:7], v[148:151]
    v_mfma_f32_16x16x32_bf16 v[148:151], a[44:47], a[20:23], v[148:151]
    v_mfma_f32_16x16x32_bf16 v[152:155], a[40:43], a[8:11], v[152:155]
    v_mfma_f32_16x16x32_bf16 v[152:155], a[44:47], a[24:27], v[152:155]
    v_mfma_f32_16x16x32_bf16 v[156:159], a[40:43], a[12:15], v[156:159]
    v_mfma_f32_16x16x32_bf16 v[156:159], a[44:47], a[28:31], v[156:159]
    v_mfma_f32_16x16x32_bf16 v[160:163], a[48:51], a[0:3], v[160:163]
    v_mfma_f32_16x16x32_bf16 v[160:163], a[52:55], a[16:19], v[160:163]
    v_mfma_f32_16x16x32_bf16 v[164:167], a[48:51], a[4:7], v[164:167]
    v_mfma_f32_16x16x32_bf16 v[164:167], a[52:55], a[20:23], v[164:167]
    v_mfma_f32_16x16x32_bf16 v[168:171], a[48:51], a[8:11], v[168:171]
    v_mfma_f32_16x16x32_bf16 v[168:171], a[52:55], a[24:27], v[168:171]
    v_mfma_f32_16x16x32_bf16 v[172:175], a[48:51], a[12:15], v[172:175]
    v_mfma_f32_16x16x32_bf16 v[172:175], a[52:55], a[28:31], v[172:175]
    v_mfma_f32_16x16x32_bf16 v[176:179], a[56:59], a[0:3], v[176:179]
    v_mfma_f32_16x16x32_bf16 v[176:179], a[60:63], a[16:19], v[176:179]
    v_mfma_f32_16x16x32_bf16 v[180:183], a[56:59], a[4:7], v[180:183]
    v_mfma_f32_16x16x32_bf16 v[180:183], a[60:63], a[20:23], v[180:183]
    v_mfma_f32_16x16x32_bf16 v[184:187], a[56:59], a[8:11], v[184:187]
    v_mfma_f32_16x16x32_bf16 v[184:187], a[60:63], a[24:27], v[184:187]
    v_mfma_f32_16x16x32_bf16 v[188:191], a[56:59], a[12:15], v[188:191]
    v_mfma_f32_16x16x32_bf16 v[188:191], a[60:63], a[28:31], v[188:191]
    s_waitcnt vmcnt(0)
    s_barrier
    ds_read_b64_tr_b16 a[32:33], v8 offset:32768
    ds_read_b64_tr_b16 a[34:35], v8 offset:40960
    ds_read_b64_tr_b16 a[36:37], v8 offset:49152
    ds_read_b64_tr_b16 a[38:39], v8 offset:57344
    ds_read_b128 a[0:3], v16 offset:0
    ds_read_b128 a[16:19], v16 offset:4096
    ds_read_b128 a[4:7], v16 offset:1024
    ds_read_b128 a[20:23], v16 offset:5120
    ds_read_b128 a[8:11], v16 offset:2048
    ds_read_b128 a[24:27], v16 offset:6144
    ds_read_b128 a[12:15], v16 offset:3072
    ds_read_b128 a[28:31], v16 offset:7168
    s_setprio 1
    s_waitcnt lgkmcnt(7)
    v_mfma_f32_16x16x32_bf16 v[64:67], a[32:35], a[0:3], v[64:67]
    ds_read_b64_tr_b16 a[40:41], v9 offset:32768
    ds_read_b64_tr_b16 a[42:43], v9 offset:40960
    s_waitcnt lgkmcnt(8)
    v_mfma_f32_16x16x32_bf16 v[64:67], a[36:39], a[16:19], v[64:67]
    ds_read_b64_tr_b16 a[44:45], v9 offset:49152
    ds_read_b64_tr_b16 a[46:47], v9 offset:57344
    s_waitcnt lgkmcnt(9)
    v_mfma_f32_16x16x32_bf16 v[68:71], a[32:35], a[4:7], v[68:71]
    ds_read_b64_tr_b16 a[48:49], v10 offset:32768
    ds_read_b64_tr_b16 a[50:51], v10 offset:40960
    s_waitcnt lgkmcnt(10)
    v_mfma_f32_16x16x32_bf16 v[68:71], a[36:39], a[20:23], v[68:71]
    ds_read_b64_tr_b16 a[52:53], v10 offset:49152
    s_waitcnt lgkmcnt(10)
    v_mfma_f32_16x16x32_bf16 v[72:75], a[32:35], a[8:11], v[72:75]
    ds_read_b64_tr_b16 a[54:55], v10 offset:57344
    s_waitcnt lgkmcnt(10)
    v_mfma_f32_16x16x32_bf16 v[72:75], a[36:39], a[24:27], v[72:75]
    ds_read_b64_tr_b16 a[56:57], v11 offset:32768
    s_waitcnt lgkmcnt(10)
    v_mfma_f32_16x16x32_bf16 v[76:79], a[32:35], a[12:15], v[76:79]
    ds_read_b64_tr_b16 a[58:59], v11 offset:40960
    s_waitcnt lgkmcnt(10)
    v_mfma_f32_16x16x32_bf16 v[76:79], a[36:39], a[28:31], v[76:79]
    ds_read_b64_tr_b16 a[60:61], v11 offset:49152
    s_waitcnt lgkmcnt(9)
    v_mfma_f32_16x16x32_bf16 v[80:83], a[40:43], a[0:3], v[80:83]
    ds_read_b64_tr_b16 a[62:63], v11 offset:57344
    ds_read_b64_tr_b16 a[32:33], v12 offset:32768
    s_waitcnt lgkmcnt(9)
    v_mfma_f32_16x16x32_bf16 v[80:83], a[44:47], a[16:19], v[80:83]
    ds_read_b64_tr_b16 a[34:35], v12 offset:40960
    ds_read_b64_tr_b16 a[36:37], v12 offset:49152
    v_mfma_f32_16x16x32_bf16 v[84:87], a[40:43], a[4:7], v[84:87]
    v_mfma_f32_16x16x32_bf16 v[84:87], a[44:47], a[20:23], v[84:87]
    v_mfma_f32_16x16x32_bf16 v[88:91], a[40:43], a[8:11], v[88:91]
    v_mfma_f32_16x16x32_bf16 v[88:91], a[44:47], a[24:27], v[88:91]
    v_mfma_f32_16x16x32_bf16 v[92:95], a[40:43], a[12:15], v[92:95]
    v_mfma_f32_16x16x32_bf16 v[92:95], a[44:47], a[28:31], v[92:95]
    s_barrier
    s_waitcnt lgkmcnt(0)
    ds_read_b128 v[24:27], v23
    ds_read_b128 v[28:31], v23 offset:1024
    ds_read_b32 v22, v22
    v_mfma_f32_16x16x32_bf16 v[96:99], a[48:51], a[0:3], v[96:99]
    ds_read_b64_tr_b16 a[38:39], v12 offset:57344
    ds_read_b64_tr_b16 a[40:41], v13 offset:32768
    v_mfma_f32_16x16x32_bf16 v[96:99], a[52:55], a[16:19], v[96:99]
    ds_read_b64_tr_b16 a[42:43], v13 offset:40960
    ds_read_b64_tr_b16 a[44:45], v13 offset:49152
    v_mfma_f32_16x16x32_bf16 v[100:103], a[48:51], a[4:7], v[100:103]
    ds_read_b64_tr_b16 a[46:47], v13 offset:57344
    v_mfma_f32_16x16x32_bf16 v[100:103], a[52:55], a[20:23], v[100:103]
    v_mfma_f32_16x16x32_bf16 v[104:107], a[48:51], a[8:11], v[104:107]
    v_mfma_f32_16x16x32_bf16 v[104:107], a[52:55], a[24:27], v[104:107]
    v_mfma_f32_16x16x32_bf16 v[108:111], a[48:51], a[12:15], v[108:111]
    v_mfma_f32_16x16x32_bf16 v[108:111], a[52:55], a[28:31], v[108:111]
    s_waitcnt lgkmcnt(5)
    v_cmp_ne_u32 vcc, 0, v22
    s_cmp_lg_u32 s39, 0
    s_cbranch_scc1 L_fb_pv_skip
    s_cbranch_vccnz L_fb_pv
L_fb_pv_skip:
    v_mfma_f32_16x16x32_bf16 v[112:115], a[56:59], a[0:3], v[112:115]
    ds_read_b64_tr_b16 a[48:49], v14 offset:32768
    ds_read_b64_tr_b16 a[50:51], v14 offset:40960
    v_mfma_f32_16x16x32_bf16 v[112:115], a[60:63], a[16:19], v[112:115]
    ds_read_b64_tr_b16 a[52:53], v14 offset:49152
    ds_read_b64_tr_b16 a[54:55], v14 offset:57344
    v_mfma_f32_16x16x32_bf16 v[116:119], a[56:59], a[4:7], v[116:119]
    v_add_f32 v24, v24, v28
    v_add_f32 v25, v25, v29
    v_mfma_f32_16x16x32_bf16 v[116:119], a[60:63], a[20:23], v[116:119]
    v_add_f32 v26, v26, v30
    v_add_f32 v27, v27, v31
    v_mfma_f32_16x16x32_bf16 v[120:123], a[56:59], a[8:11], v[120:123]
    v_rcp_f32 v24, v24
    v_mfma_f32_16x16x32_bf16 v[120:123], a[60:63], a[24:27], v[120:123]
    v_rcp_f32 v25, v25
    v_mfma_f32_16x16x32_bf16 v[124:127], a[56:59], a[12:15], v[124:127]
    v_rcp_f32 v26, v26
    v_mfma_f32_16x16x32_bf16 v[124:127], a[60:63], a[28:31], v[124:127]
    v_rcp_f32 v27, v27
    v_mfma_f32_16x16x32_bf16 v[128:131], a[32:35], a[0:3], v[128:131]
    ds_read_b64_tr_b16 a[56:57], v15 offset:32768
    ds_read_b64_tr_b16 a[58:59], v15 offset:40960
    s_waitcnt lgkmcnt(10)
    v_mfma_f32_16x16x32_bf16 v[128:131], a[36:39], a[16:19], v[128:131]
    ds_read_b64_tr_b16 a[60:61], v15 offset:49152
    s_lshr_b32 s48, s54, 1
    v_mfma_f32_16x16x32_bf16 v[132:135], a[32:35], a[4:7], v[132:135]
    s_lshl_b32 s48, s48, 8
    s_and_b32 s49, s36, 1
    v_mfma_f32_16x16x32_bf16 v[132:135], a[36:39], a[20:23], v[132:135]
    s_lshl_b32 s49, s49, 15
    s_add_u32 s49, s49, s48
    v_mfma_f32_16x16x32_bf16 v[136:139], a[32:35], a[8:11], v[136:139]
    v_lshrrev_b32 v6, 1, v1
    v_xor_b32 v6, v6, v3
    v_mfma_f32_16x16x32_bf16 v[136:139], a[36:39], a[24:27], v[136:139]
    v_lshlrev_b32 v6, 4, v6
    v_lshl_add_u32 v6, v3, 9, v6
    v_mfma_f32_16x16x32_bf16 v[140:143], a[32:35], a[12:15], v[140:143]
    v_and_b32 v7, 1, v1
    v_lshl_add_u32 v6, v7, 3, v6
    v_mfma_f32_16x16x32_bf16 v[140:143], a[36:39], a[28:31], v[140:143]
    v_add_u32 v56, s49, v6
    v_xor_b32 v57, 32, v56
    s_waitcnt lgkmcnt(9)
    v_mfma_f32_16x16x32_bf16 v[144:147], a[40:43], a[0:3], v[144:147]
    ds_read_b64_tr_b16 a[62:63], v15 offset:57344
    v_xor_b32 v58, 64, v56
    s_waitcnt lgkmcnt(8)
    v_mfma_f32_16x16x32_bf16 v[144:147], a[44:47], a[16:19], v[144:147]
    v_xor_b32 v59, 96, v56
    v_xor_b32 v60, 128, v56
    v_mfma_f32_16x16x32_bf16 v[148:151], a[40:43], a[4:7], v[148:151]
    v_xor_b32 v61, 160, v56
    v_xor_b32 v62, 192, v56
    v_mfma_f32_16x16x32_bf16 v[148:151], a[44:47], a[20:23], v[148:151]
    v_xor_b32 v63, 224, v56
    v_mov_b32 v32, v24
    v_mfma_f32_16x16x32_bf16 v[152:155], a[40:43], a[8:11], v[152:155]
    v_mov_b32 v33, v24
    v_mov_b32 v34, v25
    v_mfma_f32_16x16x32_bf16 v[152:155], a[44:47], a[24:27], v[152:155]
    v_mov_b32 v35, v25
    v_mov_b32 v36, v26
    v_mfma_f32_16x16x32_bf16 v[156:159], a[40:43], a[12:15], v[156:159]
    v_mov_b32 v37, v26
    v_mov_b32 v38, v27
    v_mfma_f32_16x16x32_bf16 v[156:159], a[44:47], a[28:31], v[156:159]
    v_mov_b32 v39, v27
    v_pk_mul_f32 v[64:65], v[64:65], v[32:33]
    s_waitcnt lgkmcnt(6)
    v_mfma_f32_16x16x32_bf16 v[160:163], a[48:51], a[0:3], v[160:163]
    v_pk_mul_f32 v[66:67], v[66:67], v[32:33]
    v_pk_mul_f32 v[80:81], v[80:81], v[32:33]
    s_waitcnt lgkmcnt(4)
    v_mfma_f32_16x16x32_bf16 v[160:163], a[52:55], a[16:19], v[160:163]
    v_pk_mul_f32 v[82:83], v[82:83], v[32:33]
    v_cvt_pk_bf16_f32 v40, v64, v65
    v_mfma_f32_16x16x32_bf16 v[164:167], a[48:51], a[4:7], v[164:167]
    v_cvt_pk_bf16_f32 v41, v66, v67
    v_cvt_pk_bf16_f32 v42, v80, v81
    v_mfma_f32_16x16x32_bf16 v[164:167], a[52:55], a[20:23], v[164:167]
    v_cvt_pk_bf16_f32 v43, v82, v83
    ds_write_b64 v56, v[40:41] offset:0
    v_mfma_f32_16x16x32_bf16 v[168:171], a[48:51], a[8:11], v[168:171]
    ds_write_b64 v57, v[42:43] offset:0
    v_pk_mul_f32 v[68:69], v[68:69], v[34:35]
    v_mfma_f32_16x16x32_bf16 v[168:171], a[52:55], a[24:27], v[168:171]
    v_pk_mul_f32 v[70:71], v[70:71], v[34:35]
    v_pk_mul_f32 v[84:85], v[84:85], v[34:35]
    v_mfma_f32_16x16x32_bf16 v[172:175], a[48:51], a[12:15], v[172:175]
    v_pk_mul_f32 v[86:87], v[86:87], v[34:35]
    v_cvt_pk_bf16_f32 v44, v68, v69
    v_mfma_f32_16x16x32_bf16 v[172:175], a[52:55], a[28:31], v[172:175]
    v_cvt_pk_bf16_f32 v45, v70, v71
    v_cvt_pk_bf16_f32 v46, v84, v85
    s_waitcnt lgkmcnt(4)
    v_mfma_f32_16x16x32_bf16 v[176:179], a[56:59], a[0:3], v[176:179]
    v_cvt_pk_bf16_f32 v47, v86, v87
    ds_write_b64 v56, v[44:45] offset:8192
    s_waitcnt lgkmcnt(3)
    v_mfma_f32_16x16x32_bf16 v[176:179], a[60:63], a[16:19], v[176:179]
    ds_write_b64 v57, v[46:47] offset:8192
    v_pk_mul_f32 v[72:73], v[72:73], v[36:37]
    v_mfma_f32_16x16x32_bf16 v[180:183], a[56:59], a[4:7], v[180:183]
    v_pk_mul_f32 v[74:75], v[74:75], v[36:37]
    v_pk_mul_f32 v[88:89], v[88:89], v[36:37]
    v_mfma_f32_16x16x32_bf16 v[180:183], a[60:63], a[20:23], v[180:183]
    v_pk_mul_f32 v[90:91], v[90:91], v[36:37]
    v_cvt_pk_bf16_f32 v48, v72, v73
    v_mfma_f32_16x16x32_bf16 v[184:187], a[56:59], a[8:11], v[184:187]
    v_cvt_pk_bf16_f32 v49, v74, v75
    v_cvt_pk_bf16_f32 v50, v88, v89
    v_mfma_f32_16x16x32_bf16 v[184:187], a[60:63], a[24:27], v[184:187]
    v_cvt_pk_bf16_f32 v51, v90, v91
    ds_write_b64 v56, v[48:49] offset:16384
    v_mfma_f32_16x16x32_bf16 v[188:191], a[56:59], a[12:15], v[188:191]
    ds_write_b64 v57, v[50:51] offset:16384
    v_pk_mul_f32 v[76:77], v[76:77], v[38:39]
    v_mfma_f32_16x16x32_bf16 v[188:191], a[60:63], a[28:31], v[188:191]
    v_pk_mul_f32 v[78:79], v[78:79], v[38:39]
    v_pk_mul_f32 v[92:93], v[92:93], v[38:39]
    s_nop 3
    v_pk_mul_f32 v[94:95], v[94:95], v[38:39]
    v_cvt_pk_bf16_f32 v52, v76, v77
    v_cvt_pk_bf16_f32 v53, v78, v79
    v_cvt_pk_bf16_f32 v54, v92, v93
    v_cvt_pk_bf16_f32 v55, v94, v95
    ds_write_b64 v56, v[52:53] offset:24576
    ds_write_b64 v57, v[54:55] offset:24576
    v_pk_mul_f32 v[96:97], v[96:97], v[32:33]
    v_pk_mul_f32 v[98:99], v[98:99], v[32:33]
    v_pk_mul_f32 v[112:113], v[112:113], v[32:33]
    v_pk_mul_f32 v[114:115], v[114:115], v[32:33]
    v_cvt_pk_bf16_f32 v40, v96, v97
    v_cvt_pk_bf16_f32 v41, v98, v99
    v_cvt_pk_bf16_f32 v42, v112, v113
    v_cvt_pk_bf16_f32 v43, v114, v115
    ds_write_b64 v58, v[40:41] offset:0
    ds_write_b64 v59, v[42:43] offset:0
    v_pk_mul_f32 v[100:101], v[100:101], v[34:35]
    v_pk_mul_f32 v[102:103], v[102:103], v[34:35]
    v_pk_mul_f32 v[116:117], v[116:117], v[34:35]
    v_pk_mul_f32 v[118:119], v[118:119], v[34:35]
    v_cvt_pk_bf16_f32 v44, v100, v101
    v_cvt_pk_bf16_f32 v45, v102, v103
    v_cvt_pk_bf16_f32 v46, v116, v117
    v_cvt_pk_bf16_f32 v47, v118, v119
    ds_write_b64 v58, v[44:45] offset:8192
    ds_write_b64 v59, v[46:47] offset:8192
    v_pk_mul_f32 v[104:105], v[104:105], v[36:37]
    v_pk_mul_f32 v[106:107], v[106:107], v[36:37]
    v_pk_mul_f32 v[120:121], v[120:121], v[36:37]
    v_pk_mul_f32 v[122:123], v[122:123], v[36:37]
    v_cvt_pk_bf16_f32 v48, v104, v105
    v_cvt_pk_bf16_f32 v49, v106, v107
    v_cvt_pk_bf16_f32 v50, v120, v121
    v_cvt_pk_bf16_f32 v51, v122, v123
    ds_write_b64 v58, v[48:49] offset:16384
    ds_write_b64 v59, v[50:51] offset:16384
    v_pk_mul_f32 v[108:109], v[108:109], v[38:39]
    v_pk_mul_f32 v[110:111], v[110:111], v[38:39]
    v_pk_mul_f32 v[124:125], v[124:125], v[38:39]
    v_pk_mul_f32 v[126:127], v[126:127], v[38:39]
    v_cvt_pk_bf16_f32 v52, v108, v109
    v_cvt_pk_bf16_f32 v53, v110, v111
    v_cvt_pk_bf16_f32 v54, v124, v125
    v_cvt_pk_bf16_f32 v55, v126, v127
    s_waitcnt lgkmcnt(6)
    ds_write_b64 v58, v[52:53] offset:24576
    ds_write_b64 v59, v[54:55] offset:24576
    v_pk_mul_f32 v[128:129], v[128:129], v[32:33]
    v_pk_mul_f32 v[130:131], v[130:131], v[32:33]
    v_pk_mul_f32 v[144:145], v[144:145], v[32:33]
    v_pk_mul_f32 v[146:147], v[146:147], v[32:33]
    v_cvt_pk_bf16_f32 v40, v128, v129
    v_cvt_pk_bf16_f32 v41, v130, v131
    v_cvt_pk_bf16_f32 v42, v144, v145
    v_cvt_pk_bf16_f32 v43, v146, v147
    ds_write_b64 v60, v[40:41] offset:0
    ds_write_b64 v61, v[42:43] offset:0
    v_pk_mul_f32 v[132:133], v[132:133], v[34:35]
    v_pk_mul_f32 v[134:135], v[134:135], v[34:35]
    v_pk_mul_f32 v[148:149], v[148:149], v[34:35]
    v_pk_mul_f32 v[150:151], v[150:151], v[34:35]
    v_cvt_pk_bf16_f32 v44, v132, v133
    v_cvt_pk_bf16_f32 v45, v134, v135
    v_cvt_pk_bf16_f32 v46, v148, v149
    v_cvt_pk_bf16_f32 v47, v150, v151
    ds_write_b64 v60, v[44:45] offset:8192
    ds_write_b64 v61, v[46:47] offset:8192
    v_pk_mul_f32 v[136:137], v[136:137], v[36:37]
    v_pk_mul_f32 v[138:139], v[138:139], v[36:37]
    v_pk_mul_f32 v[152:153], v[152:153], v[36:37]
    v_pk_mul_f32 v[154:155], v[154:155], v[36:37]
    v_cvt_pk_bf16_f32 v48, v136, v137
    v_cvt_pk_bf16_f32 v49, v138, v139
    v_cvt_pk_bf16_f32 v50, v152, v153
    v_cvt_pk_bf16_f32 v51, v154, v155
    ds_write_b64 v60, v[48:49] offset:16384
    ds_write_b64 v61, v[50:51] offset:16384
    v_pk_mul_f32 v[140:141], v[140:141], v[38:39]
    v_pk_mul_f32 v[142:143], v[142:143], v[38:39]
    v_pk_mul_f32 v[156:157], v[156:157], v[38:39]
    v_pk_mul_f32 v[158:159], v[158:159], v[38:39]
    v_cvt_pk_bf16_f32 v52, v140, v141
    v_cvt_pk_bf16_f32 v53, v142, v143
    v_cvt_pk_bf16_f32 v54, v156, v157
    v_cvt_pk_bf16_f32 v55, v158, v159
    s_waitcnt lgkmcnt(6)
    ds_write_b64 v60, v[52:53] offset:24576
    ds_write_b64 v61, v[54:55] offset:24576
    s_nop 3
    v_pk_mul_f32 v[160:161], v[160:161], v[32:33]
    v_pk_mul_f32 v[162:163], v[162:163], v[32:33]
    v_pk_mul_f32 v[176:177], v[176:177], v[32:33]
    v_pk_mul_f32 v[178:179], v[178:179], v[32:33]
    v_cvt_pk_bf16_f32 v40, v160, v161
    v_cvt_pk_bf16_f32 v41, v162, v163
    v_cvt_pk_bf16_f32 v42, v176, v177
    v_cvt_pk_bf16_f32 v43, v178, v179
    ds_write_b64 v62, v[40:41] offset:0
    ds_write_b64 v63, v[42:43] offset:0
    v_pk_mul_f32 v[164:165], v[164:165], v[34:35]
    v_pk_mul_f32 v[166:167], v[166:167], v[34:35]
    v_pk_mul_f32 v[180:181], v[180:181], v[34:35]
    v_pk_mul_f32 v[182:183], v[182:183], v[34:35]
    v_cvt_pk_bf16_f32 v44, v164, v165
    v_cvt_pk_bf16_f32 v45, v166, v167
    v_cvt_pk_bf16_f32 v46, v180, v181
    v_cvt_pk_bf16_f32 v47, v182, v183
    ds_write_b64 v62, v[44:45] offset:8192
    ds_write_b64 v63, v[46:47] offset:8192
    v_pk_mul_f32 v[168:169], v[168:169], v[36:37]
    v_pk_mul_f32 v[170:171], v[170:171], v[36:37]
    v_pk_mul_f32 v[184:185], v[184:185], v[36:37]
    v_pk_mul_f32 v[186:187], v[186:187], v[36:37]
    v_cvt_pk_bf16_f32 v48, v168, v169
    v_cvt_pk_bf16_f32 v49, v170, v171
    v_cvt_pk_bf16_f32 v50, v184, v185
    v_cvt_pk_bf16_f32 v51, v186, v187
    ds_write_b64 v62, v[48:49] offset:16384
    ds_write_b64 v63, v[50:51] offset:16384
    v_pk_mul_f32 v[172:173], v[172:173], v[38:39]
    v_pk_mul_f32 v[174:175], v[174:175], v[38:39]
    v_pk_mul_f32 v[188:189], v[188:189], v[38:39]
    v_pk_mul_f32 v[190:191], v[190:191], v[38:39]
    v_cvt_pk_bf16_f32 v52, v172, v173
    v_cvt_pk_bf16_f32 v53, v174, v175
    v_cvt_pk_bf16_f32 v54, v188, v189
    v_cvt_pk_bf16_f32 v55, v190, v191
    s_waitcnt lgkmcnt(6)
    ds_write_b64 v62, v[52:53] offset:24576
    ds_write_b64 v63, v[54:55] offset:24576
    s_waitcnt lgkmcnt(0)
    s_barrier
    v_lshrrev_b32 v4, 5, v2
    v_and_b32 v6, 31, v2
    v_xor_b32 v6, v6, v4
    v_lshlrev_b32 v6, 4, v6
    v_lshl_add_u32 v6, v4, 9, v6
    s_lshl_b32 s48, s36, 13
    v_lshlrev_b32 v7, 4, v2
    v_add_u32 v7, s48, v7
    s_add_u32 s48, s48, s53
    ds_read_b128 v[16:19], v7 offset:0
    ds_read_b128 v[20:23], v7 offset:1024
    ds_read_b128 v[24:27], v7 offset:2048
    ds_read_b128 v[28:31], v7 offset:3072
    ds_read_b128 v[32:35], v7 offset:4096
    ds_read_b128 v[36:39], v7 offset:5120
    ds_read_b128 v[40:43], v7 offset:6144
    ds_read_b128 v[44:47], v7 offset:7168
    v_xor_b32 v8, 0, v6
    v_xor_b32 v9, 32, v6
    v_xor_b32 v10, 64, v6
    v_xor_b32 v11, 96, v6
    v_xor_b32 v12, 128, v6
    v_xor_b32 v13, 160, v6
    v_xor_b32 v14, 192, v6
    v_xor_b32 v15, 224, v6
    s_waitcnt lgkmcnt(7)
    buffer_store_dwordx4 v[16:19], v8, s[28:31], s48 offen offset:0 nt
    s_waitcnt lgkmcnt(6)
    buffer_store_dwordx4 v[20:23], v9, s[28:31], s48 offen offset:1024 nt
    s_waitcnt lgkmcnt(5)
    buffer_store_dwordx4 v[24:27], v10, s[28:31], s48 offen offset:2048 nt
    s_waitcnt lgkmcnt(4)
    buffer_store_dwordx4 v[28:31], v11, s[28:31], s48 offen offset:3072 nt
    s_add_u32 s48, s48, 4096
    s_waitcnt lgkmcnt(3)
    buffer_store_dwordx4 v[32:35], v12, s[28:31], s48 offen offset:0 nt
    s_waitcnt lgkmcnt(2)
    buffer_store_dwordx4 v[36:39], v13, s[28:31], s48 offen offset:1024 nt
    s_waitcnt lgkmcnt(1)
    buffer_store_dwordx4 v[40:43], v14, s[28:31], s48 offen offset:2048 nt
    s_waitcnt lgkmcnt(0)
    buffer_store_dwordx4 v[44:47], v15, s[28:31], s48 offen offset:3072 nt
    s_branch L_end
L_fb_pv:
    s_mov_b32 s39, 1
    s_waitcnt vmcnt(0) lgkmcnt(0)
    s_lshl_b32 s41, s37, 20
    s_mov_b32 s40, 32
L_fb_pv_loop:
    s_barrier
    s_add_u32 m0, s43, 0
    s_nop 0
    buffer_load_dwordx4 v17, s[20:23], s41 offen nt lds
    buffer_load_dwordx4 v18, s[20:23], s41 offen offset:1024 nt lds
    s_add_u32 s41, s41, 8192
    s_add_u32 m0, s43, 8192
    s_nop 0
    buffer_load_dwordx4 v17, s[20:23], s41 offen nt lds
    buffer_load_dwordx4 v18, s[20:23], s41 offen offset:1024 nt lds
    s_add_u32 s41, s41, 8192
    s_add_u32 m0, s43, 16384
    s_nop 0
    buffer_load_dwordx4 v17, s[20:23], s41 offen nt lds
    buffer_load_dwordx4 v18, s[20:23], s41 offen offset:1024 nt lds
    s_add_u32 s41, s41, 8192
    s_add_u32 m0, s43, 24576
    s_nop 0
    buffer_load_dwordx4 v17, s[20:23], s41 offen nt lds
    buffer_load_dwordx4 v18, s[20:23], s41 offen offset:1024 nt lds
    s_add_u32 s41, s41, 8192
    s_waitcnt vmcnt(0)
    s_barrier
    s_sub_u32 s40, s40, 1
    s_cmp_lg_u32 s40, 0
    s_cbranch_scc1 L_fb_pv_loop
    s_barrier
    s_lshl_b32 s41, s37, 20
    s_mov_b32 s42, s41
    s_add_u32 m0, s43, 0
    s_nop 0
    buffer_load_dwordx4 v17, s[20:23], s41 offen nt lds
    buffer_load_dwordx4 v18, s[20:23], s41 offen offset:1024 nt lds
    s_add_u32 s41, s41, 8192
    s_add_u32 m0, s43, 8192
    s_nop 0
    buffer_load_dwordx4 v17, s[20:23], s41 offen nt lds
    buffer_load_dwordx4 v18, s[20:23], s41 offen offset:1024 nt lds
    s_add_u32 s41, s41, 8192
    s_add_u32 m0, s43, 16384
    s_nop 0
    buffer_load_dwordx4 v17, s[20:23], s41 offen nt lds
    buffer_load_dwordx4 v18, s[20:23], s41 offen offset:1024 nt lds
    s_add_u32 s41, s41, 8192
    s_add_u32 m0, s43, 24576
    s_nop 0
    buffer_load_dwordx4 v17, s[20:23], s41 offen nt lds
    buffer_load_dwordx4 v18, s[20:23], s41 offen offset:1024 nt lds
    s_add_u32 s41, s41, 8192
    s_add_u32 m0, s43, 32768
    s_nop 0
    buffer_load_dwordx4 v17, s[20:23], s41 offen nt lds
    buffer_load_dwordx4 v18, s[20:23], s41 offen offset:1024 nt lds
    s_add_u32 s41, s41, 8192
    s_add_u32 m0, s43, 40960
    s_nop 0
    buffer_load_dwordx4 v17, s[20:23], s41 offen nt lds
    buffer_load_dwordx4 v18, s[20:23], s41 offen offset:1024 nt lds
    s_add_u32 s41, s41, 8192
    s_add_u32 m0, s43, 49152
    s_nop 0
    buffer_load_dwordx4 v17, s[20:23], s41 offen nt lds
    buffer_load_dwordx4 v18, s[20:23], s41 offen offset:1024 nt lds
    s_add_u32 s41, s41, 8192
    s_add_u32 m0, s43, 57344
    s_nop 0
    buffer_load_dwordx4 v17, s[20:23], s41 offen nt lds
    buffer_load_dwordx4 v18, s[20:23], s41 offen offset:1024 nt lds
    s_add_u32 s41, s41, 8192
    s_add_u32 m0, s44, 0
    s_nop 0
    buffer_load_dwordx4 v19, s[24:27], s42 offen nt lds
    buffer_load_dwordx4 v20, s[24:27], s42 offen offset:1024 nt lds
    s_add_u32 s42, s42, 8192
    s_add_u32 m0, s44, 8192
    s_nop 0
    buffer_load_dwordx4 v19, s[24:27], s42 offen nt lds
    buffer_load_dwordx4 v20, s[24:27], s42 offen offset:1024 nt lds
    s_add_u32 s42, s42, 8192
    s_add_u32 m0, s44, 16384
    s_nop 0
    buffer_load_dwordx4 v19, s[24:27], s42 offen nt lds
    buffer_load_dwordx4 v20, s[24:27], s42 offen offset:1024 nt lds
    s_add_u32 s42, s42, 8192
    s_add_u32 m0, s44, 24576
    s_nop 0
    buffer_load_dwordx4 v19, s[24:27], s42 offen nt lds
    buffer_load_dwordx4 v20, s[24:27], s42 offen offset:1024 nt lds
    s_add_u32 s42, s42, 8192
    v_mov_b32 v64, 0
    v_mov_b32 v65, 0
    v_mov_b32 v66, 0
    v_mov_b32 v67, 0
    v_mov_b32 v68, 0
    v_mov_b32 v69, 0
    v_mov_b32 v70, 0
    v_mov_b32 v71, 0
    v_mov_b32 v72, 0
    v_mov_b32 v73, 0
    v_mov_b32 v74, 0
    v_mov_b32 v75, 0
    v_mov_b32 v76, 0
    v_mov_b32 v77, 0
    v_mov_b32 v78, 0
    v_mov_b32 v79, 0
    v_mov_b32 v80, 0
    v_mov_b32 v81, 0
    v_mov_b32 v82, 0
    v_mov_b32 v83, 0
    v_mov_b32 v84, 0
    v_mov_b32 v85, 0
    v_mov_b32 v86, 0
    v_mov_b32 v87, 0
    v_mov_b32 v88, 0
    v_mov_b32 v89, 0
    v_mov_b32 v90, 0
    v_mov_b32 v91, 0
    v_mov_b32 v92, 0
    v_mov_b32 v93, 0
    v_mov_b32 v94, 0
    v_mov_b32 v95, 0
    v_mov_b32 v96, 0
    v_mov_b32 v97, 0
    v_mov_b32 v98, 0
    v_mov_b32 v99, 0
    v_mov_b32 v100, 0
    v_mov_b32 v101, 0
    v_mov_b32 v102, 0
    v_mov_b32 v103, 0
    v_mov_b32 v104, 0
    v_mov_b32 v105, 0
    v_mov_b32 v106, 0
    v_mov_b32 v107, 0
    v_mov_b32 v108, 0
    v_mov_b32 v109, 0
    v_mov_b32 v110, 0
    v_mov_b32 v111, 0
    v_mov_b32 v112, 0
    v_mov_b32 v113, 0
    v_mov_b32 v114, 0
    v_mov_b32 v115, 0
    v_mov_b32 v116, 0
    v_mov_b32 v117, 0
    v_mov_b32 v118, 0
    v_mov_b32 v119, 0
    v_mov_b32 v120, 0
    v_mov_b32 v121, 0
    v_mov_b32 v122, 0
    v_mov_b32 v123, 0
    v_mov_b32 v124, 0
    v_mov_b32 v125, 0
    v_mov_b32 v126, 0
    v_mov_b32 v127, 0
    v_mov_b32 v128, 0
    v_mov_b32 v129, 0
    v_mov_b32 v130, 0
    v_mov_b32 v131, 0
    v_mov_b32 v132, 0
    v_mov_b32 v133, 0
    v_mov_b32 v134, 0
    v_mov_b32 v135, 0
    v_mov_b32 v136, 0
    v_mov_b32 v137, 0
    v_mov_b32 v138, 0
    v_mov_b32 v139, 0
    v_mov_b32 v140, 0
    v_mov_b32 v141, 0
    v_mov_b32 v142, 0
    v_mov_b32 v143, 0
    v_mov_b32 v144, 0
    v_mov_b32 v145, 0
    v_mov_b32 v146, 0
    v_mov_b32 v147, 0
    v_mov_b32 v148, 0
    v_mov_b32 v149, 0
    v_mov_b32 v150, 0
    v_mov_b32 v151, 0
    v_mov_b32 v152, 0
    v_mov_b32 v153, 0
    v_mov_b32 v154, 0
    v_mov_b32 v155, 0
    v_mov_b32 v156, 0
    v_mov_b32 v157, 0
    v_mov_b32 v158, 0
    v_mov_b32 v159, 0
    v_mov_b32 v160, 0
    v_mov_b32 v161, 0
    v_mov_b32 v162, 0
    v_mov_b32 v163, 0
    v_mov_b32 v164, 0
    v_mov_b32 v165, 0
    v_mov_b32 v166, 0
    v_mov_b32 v167, 0
    v_mov_b32 v168, 0
    v_mov_b32 v169, 0
    v_mov_b32 v170, 0
    v_mov_b32 v171, 0
    v_mov_b32 v172, 0
    v_mov_b32 v173, 0
    v_mov_b32 v174, 0
    v_mov_b32 v175, 0
    v_mov_b32 v176, 0
    v_mov_b32 v177, 0
    v_mov_b32 v178, 0
    v_mov_b32 v179, 0
    v_mov_b32 v180, 0
    v_mov_b32 v181, 0
    v_mov_b32 v182, 0
    v_mov_b32 v183, 0
    v_mov_b32 v184, 0
    v_mov_b32 v185, 0
    v_mov_b32 v186, 0
    v_mov_b32 v187, 0
    v_mov_b32 v188, 0
    v_mov_b32 v189, 0
    v_mov_b32 v190, 0
    v_mov_b32 v191, 0
    v_accvgpr_write_b32 a0, 0
    v_accvgpr_write_b32 a1, 0
    v_accvgpr_write_b32 a2, 0
    v_accvgpr_write_b32 a3, 0
    v_accvgpr_write_b32 a4, 0
    v_accvgpr_write_b32 a5, 0
    v_accvgpr_write_b32 a6, 0
    v_accvgpr_write_b32 a7, 0
    v_accvgpr_write_b32 a8, 0
    v_accvgpr_write_b32 a9, 0
    v_accvgpr_write_b32 a10, 0
    v_accvgpr_write_b32 a11, 0
    v_accvgpr_write_b32 a12, 0
    v_accvgpr_write_b32 a13, 0
    v_accvgpr_write_b32 a14, 0
    v_accvgpr_write_b32 a15, 0
    v_accvgpr_write_b32 a16, 0
    v_accvgpr_write_b32 a17, 0
    v_accvgpr_write_b32 a18, 0
    v_accvgpr_write_b32 a19, 0
    v_accvgpr_write_b32 a20, 0
    v_accvgpr_write_b32 a21, 0
    v_accvgpr_write_b32 a22, 0
    v_accvgpr_write_b32 a23, 0
    v_accvgpr_write_b32 a24, 0
    v_accvgpr_write_b32 a25, 0
    v_accvgpr_write_b32 a26, 0
    v_accvgpr_write_b32 a27, 0
    v_accvgpr_write_b32 a28, 0
    v_accvgpr_write_b32 a29, 0
    v_accvgpr_write_b32 a30, 0
    v_accvgpr_write_b32 a31, 0
    v_accvgpr_write_b32 a32, 0
    v_accvgpr_write_b32 a33, 0
    v_accvgpr_write_b32 a34, 0
    v_accvgpr_write_b32 a35, 0
    v_accvgpr_write_b32 a36, 0
    v_accvgpr_write_b32 a37, 0
    v_accvgpr_write_b32 a38, 0
    v_accvgpr_write_b32 a39, 0
    v_accvgpr_write_b32 a40, 0
    v_accvgpr_write_b32 a41, 0
    v_accvgpr_write_b32 a42, 0
    v_accvgpr_write_b32 a43, 0
    v_accvgpr_write_b32 a44, 0
    v_accvgpr_write_b32 a45, 0
    v_accvgpr_write_b32 a46, 0
    v_accvgpr_write_b32 a47, 0
    v_accvgpr_write_b32 a48, 0
    v_accvgpr_write_b32 a49, 0
    v_accvgpr_write_b32 a50, 0
    v_accvgpr_write_b32 a51, 0
    v_accvgpr_write_b32 a52, 0
    v_accvgpr_write_b32 a53, 0
    v_accvgpr_write_b32 a54, 0
    v_accvgpr_write_b32 a55, 0
    v_accvgpr_write_b32 a56, 0
    v_accvgpr_write_b32 a57, 0
    v_accvgpr_write_b32 a58, 0
    v_accvgpr_write_b32 a59, 0
    v_accvgpr_write_b32 a60, 0
    v_accvgpr_write_b32 a61, 0
    v_accvgpr_write_b32 a62, 0
    v_accvgpr_write_b32 a63, 0
    s_waitcnt vmcnt(16)
    s_barrier
    s_barrier
    s_add_u32 m0, s43, 0
    s_nop 0
    buffer_load_dwordx4 v17, s[20:23], s41 offen nt lds
    buffer_load_dwordx4 v18, s[20:23], s41 offen offset:1024 nt lds
    s_add_u32 s41, s41, 8192
    s_add_u32 m0, s43, 8192
    s_nop 0
    buffer_load_dwordx4 v17, s[20:23], s41 offen nt lds
    buffer_load_dwordx4 v18, s[20:23], s41 offen offset:1024 nt lds
    s_add_u32 s41, s41, 8192
    s_add_u32 m0, s43, 16384
    s_nop 0
    buffer_load_dwordx4 v17, s[20:23], s41 offen nt lds
    buffer_load_dwordx4 v18, s[20:23], s41 offen offset:1024 nt lds
    s_add_u32 s41, s41, 8192
    s_add_u32 m0, s43, 24576
    s_nop 0
    buffer_load_dwordx4 v17, s[20:23], s41 offen nt lds
    buffer_load_dwordx4 v18, s[20:23], s41 offen offset:1024 nt lds
    s_add_u32 s41, s41, 8192
    s_waitcnt vmcnt(16)
    s_branch L_pv_main
L_end:
L_done:
    s_endpgm

.section .rodata,"a"
.p2align 6
.amdhsa_kernel standalone__softmax_full_bidir__prompt_kernel
  .amdhsa_next_free_vgpr 256
  .amdhsa_next_free_sgpr 102
  .amdhsa_accum_offset 192
  .amdhsa_group_segment_fixed_size 0
  .amdhsa_kernarg_size 48
  .amdhsa_user_sgpr_count 2
  .amdhsa_user_sgpr_kernarg_segment_ptr 1
  .amdhsa_system_sgpr_workgroup_id_x 1
.end_amdhsa_kernel
```
